```python
import torch

def _softmax(x, axis=-1):
    return torch.softmax(x, dim=axis)
def _gelu(x):
    return torch.nn.functional.gelu(x, approximate="tanh")
def _silu(x):
    return torch.nn.functional.silu(x)
def _sigmoid(x):
    return torch.sigmoid(x)
def _layernorm(x, axis=-1, eps=1e-5):
    m = x.mean(dim=axis, keepdim=True)
    v = x.var(dim=axis, keepdim=True, unbiased=False)
    return (x - m) / torch.sqrt(v + eps)
def _scatter_add(tgt, idx, src, axis=0):
    return tgt.clone().index_add_(axis, idx, src)
def _segment_sum(src, seg, n):
    out = torch.zeros((n,) + src.shape[1:], dtype=src.dtype)
    return out.index_add_(0, seg, src)
def _pad(x, pw):
    flat = tuple(v for pair in reversed(pw) for v in pair)
    return torch.nn.functional.pad(x, flat)

kernel_name = 'recurrent_scan__gqa_block_cached__dense_activation_gelu__decode'

def setup_inputs():

    _w = (lambda a: (lambda t: t.to(torch.bfloat16) if t.is_floating_point() else t)(torch.as_tensor(a)))
    def _A_setup():
        B, Sq, D = 8, 1, 448
        Hq, Hkv, Sk, Dh = 16, 8, 8192, 256
        assert Hq % Hkv == 0, (Hq, Hkv)
        return {
            "x": _w((lambda *s: torch.randn(*s, dtype=torch.bfloat16) * 0.05)(B, Sq, D)),
            "k_cache": _w((lambda *s: torch.randn(*s, dtype=torch.bfloat16) * 3.2)(B, Hkv, Sk, Dh)),
            "v_cache": _w((lambda *s: torch.randn(*s, dtype=torch.bfloat16) * 3.2)(B, Hkv, Sk, Dh)),
            "wq": _w((lambda *s: torch.randn(*s, dtype=torch.bfloat16) * 3.2)(D, Hq * Dh) * (D ** -0.5)),
            "wo": _w((lambda *s: torch.randn(*s, dtype=torch.bfloat16) * 3.2)(Hq * Dh, D) * ((Hq * Dh) ** -0.5)),
        }
    _A_in = _A_setup()

    def _B_setup():
        B, S, D, F = 8, 1, 448, 1792
        return {
            "x": _w((lambda *s: torch.randn(*s, dtype=torch.bfloat16) * 0.05)(B, S, D)),
            "w1": _w((lambda *s: torch.randn(*s, dtype=torch.bfloat16) * 3.2)(D, F) * (D ** -0.5)),
            "b1": _w((lambda *s: torch.randn(*s, dtype=torch.bfloat16) * 3.2)(F) * 0.01),
            "w2": _w((lambda *s: torch.randn(*s, dtype=torch.bfloat16) * 0.8)(F, D) * (F ** -0.5)),
            "b2": _w((lambda *s: torch.randn(*s, dtype=torch.bfloat16) * 0.8)(D) * 0.01),
        }
    _B_in = _B_setup()

    return {
        "A_x": _A_in["x"],
        "A_k_cache": _A_in["k_cache"],
        "A_v_cache": _A_in["v_cache"],
        "A_wq": _A_in["wq"],
        "A_wo": _A_in["wo"],
        "B_x": _B_in["x"],
        "B_w1": _B_in["w1"],
        "B_b1": _B_in["b1"],
        "B_w2": _B_in["w2"],
        "B_b2": _B_in["b2"],
    }

def reference(A_x, A_k_cache, A_v_cache, A_wq, A_wo, B_x, B_w1, B_b1, B_w2, B_b2):
    def _A_ref(x, k_cache, v_cache, wq, wo):
        B, Sq, D = x.shape
        Hq, Dh = 16, 256
        Hkv = k_cache.shape[1]
        rep = Hq // Hkv
        q = (lambda x, *d: x.permute(*d))((x @ wq).reshape(B, Sq, Hq, Dh), 0, 2, 1, 3)
        k = (lambda x, n, axis: torch.repeat_interleave(x, n, dim=axis))(k_cache, rep, axis=1)
        v = (lambda x, n, axis: torch.repeat_interleave(x, n, dim=axis))(v_cache, rep, axis=1)
        scores = torch.einsum("bhqd,bhkd->bhqk", q, k) * (Dh ** -0.5)
        p = _softmax(scores, axis=-1)
        o = torch.einsum("bhqk,bhkd->bhqd", p, v)
        return (lambda x, *d: x.permute(*d))(o, 0, 2, 1, 3).reshape(B, Sq, Hq * Dh) @ wo

    def _B_ref(x, w1, b1, w2, b2):
        h = torch.einsum("bsd,df->bsf", x, w1) + b1
        h = _gelu(h)
        return torch.einsum("bsf,fd->bsd", h, w2) + b2

    x = A_x
    xn = _layernorm(x, axis=-1)
    s = _A_ref(xn, A_k_cache, A_v_cache, A_wq, A_wo)
    g = _silu(_B_ref(xn, B_w1, B_b1, B_w2, B_b2))
    return x + s * g
```

```asm
; @launch grid=(256,1,1) block=(256,1,1) lds=163840
.amdgcn_target "amdgcn-amd-amdhsa--gfx950"
.text
.globl recurrent_scan__gqa_block_cached__dense_activation_gelu__decode_kernel
.p2align 8
.type recurrent_scan__gqa_block_cached__dense_activation_gelu__decode_kernel,@function
recurrent_scan__gqa_block_cached__dense_activation_gelu__decode_kernel:
    s_cmp_ge_u32 s2, 256
    s_cbranch_scc1 L_end
    s_load_dwordx16 s[64:79], s[0:1], 0
    s_load_dwordx8 s[80:87], s[0:1], 64
    s_load_dwordx2 s[88:89], s[0:1], 96
    v_lshrrev_b32 v1, 6, v0
    v_and_b32 v2, 63, v0
    v_readfirstlane_b32 s3, v1
    v_and_b32 v3, 15, v2
    v_lshrrev_b32 v4, 4, v2
    v_lshrrev_b32 v5, 5, v2
    v_and_b32 v6, 31, v2
    s_lshl_b32 s23, s2, 20
    s_lshl_b32 s22, s3, 13
    s_add_u32 s23, s23, s22
    s_mov_b32 s22, 0
    s_mov_b32 s27, 0x80000000
    s_lshl_b32 s25, s3, 15
    s_add_u32 s32, s25, 0
    s_add_u32 s33, s25, 4096
    s_add_u32 s34, s25, 8192
    s_add_u32 s35, s25, 12288
    s_add_u32 s36, s25, 16384
    s_add_u32 s37, s25, 20480
    s_add_u32 s38, s25, 24576
    s_add_u32 s39, s25, 28672
    s_mul_i32 s44, s2, 9363
    s_lshr_b32 s44, s44, 16
    s_mul_i32 s45, s44, 7
    s_sub_u32 s45, s2, s45
    s_and_b32 s46, s2, 7
    s_lshr_b32 s47, s2, 3
    v_lshlrev_b32 v8, 9, v5
    v_or_b32 v9, 0, v5
    v_xor_b32 v9, v9, v6
    v_lshl_add_u32 v112, v9, 4, v8
    v_or_b32 v9, 0, v5
    v_lshlrev_b32 v9, 1, v9
    v_xor_b32 v9, v9, v6
    v_lshl_add_u32 v120, v9, 4, v8
    v_or_b32 v9, 2, v5
    v_xor_b32 v9, v9, v6
    v_lshl_add_u32 v113, v9, 4, v8
    v_or_b32 v9, 2, v5
    v_lshlrev_b32 v9, 1, v9
    v_xor_b32 v9, v9, v6
    v_lshl_add_u32 v121, v9, 4, v8
    v_or_b32 v9, 4, v5
    v_xor_b32 v9, v9, v6
    v_lshl_add_u32 v114, v9, 4, v8
    v_or_b32 v9, 4, v5
    v_lshlrev_b32 v9, 1, v9
    v_xor_b32 v9, v9, v6
    v_lshl_add_u32 v122, v9, 4, v8
    v_or_b32 v9, 6, v5
    v_xor_b32 v9, v9, v6
    v_lshl_add_u32 v115, v9, 4, v8
    v_or_b32 v9, 6, v5
    v_lshlrev_b32 v9, 1, v9
    v_xor_b32 v9, v9, v6
    v_lshl_add_u32 v123, v9, 4, v8
    v_or_b32 v9, 8, v5
    v_xor_b32 v9, v9, v6
    v_lshl_add_u32 v116, v9, 4, v8
    v_add_u32 v116, 4096, v116
    v_or_b32 v9, 0, v5
    v_lshlrev_b32 v9, 1, v9
    v_xor_b32 v9, v9, v6
    v_lshl_add_u32 v124, v9, 4, v8
    v_add_u32 v124, 4096, v124
    v_or_b32 v9, 10, v5
    v_xor_b32 v9, v9, v6
    v_lshl_add_u32 v117, v9, 4, v8
    v_add_u32 v117, 4096, v117
    v_or_b32 v9, 2, v5
    v_lshlrev_b32 v9, 1, v9
    v_xor_b32 v9, v9, v6
    v_lshl_add_u32 v125, v9, 4, v8
    v_add_u32 v125, 4096, v125
    v_or_b32 v9, 12, v5
    v_xor_b32 v9, v9, v6
    v_lshl_add_u32 v118, v9, 4, v8
    v_add_u32 v118, 4096, v118
    v_or_b32 v9, 4, v5
    v_lshlrev_b32 v9, 1, v9
    v_xor_b32 v9, v9, v6
    v_lshl_add_u32 v126, v9, 4, v8
    v_add_u32 v126, 4096, v126
    v_or_b32 v9, 14, v5
    v_xor_b32 v9, v9, v6
    v_lshl_add_u32 v119, v9, 4, v8
    v_add_u32 v119, 4096, v119
    v_or_b32 v9, 6, v5
    v_lshlrev_b32 v9, 1, v9
    v_xor_b32 v9, v9, v6
    v_lshl_add_u32 v127, v9, 4, v8
    v_add_u32 v127, 4096, v127
    v_lshl_add_u32 v7, v1, 1, v5
    v_mul_u32_u24 v7, 896, v7
    v_lshl_add_u32 v7, v6, 2, v7
    s_waitcnt lgkmcnt(0)
    s_mov_b32 s4, s66
    s_and_b32 s5, s67, 0xffff
    s_mov_b32 s6, 0x10000000
    s_mov_b32 s7, 0x00020000
    s_mov_b32 s8, s68
    s_and_b32 s9, s69, 0xffff
    s_mov_b32 s10, 0x10000000
    s_mov_b32 s11, 0x00020000
    s_mov_b32 s12, s88
    s_and_b32 s13, s89, 0xffff
    s_mov_b32 s14, 0x40000000
    s_mov_b32 s15, 0x00020000
    s_mov_b32 s16, s64
    s_and_b32 s17, s65, 0xffff
    s_mov_b32 s18, 0x1c00
    s_mov_b32 s19, 0x00020000
    s_mov_b32 s48, s86
    s_and_b32 s49, s87, 0xffff
    s_mov_b32 s50, 0x100
    s_mov_b32 s51, 0x00020000
    s_cmp_eq_u32 s3, 0
    s_cbranch_scc1 L_w0
    s_cmp_eq_u32 s3, 1
    s_cbranch_scc1 L_w1
    s_cmp_eq_u32 s3, 2
    s_cbranch_scc1 L_w2
    v_mov_b32 v16, 0
    v_mov_b32 v17, 0
    v_mov_b32 v18, 0
    v_mov_b32 v19, 0
    v_lshlrev_b32 v10, 4, v2
    s_cmp_ge_u32 s2, 161
    s_cbranch_scc1 L_w3_noclr
    s_mul_i32 s54, s45, 23
    s_add_u32 s54, s54, s44
    s_lshl_b32 s54, s54, 11
    s_add_u32 s54, s54, 720896
    buffer_store_dwordx4 v[16:19], v10, s[12:15], s54 offen sc0 sc1
    buffer_store_dwordx4 v[16:19], v10, s[12:15], s54 offen offset:1024 sc0 sc1
L_w3_noclr:
    buffer_load_dword v72, v7, s[16:19], 0 offen offset:0
    buffer_load_dword v73, v7, s[16:19], 0 offen offset:128
    buffer_load_dword v74, v7, s[16:19], 0 offen offset:256
    buffer_load_dword v75, v7, s[16:19], 0 offen offset:384
    buffer_load_dword v76, v7, s[16:19], 0 offen offset:512
    buffer_load_dword v77, v7, s[16:19], 0 offen offset:640
    buffer_load_dword v78, v7, s[16:19], 0 offen offset:768
    s_waitcnt vmcnt(0)
    v_lshlrev_b32 v80, 16, v72
    v_and_b32 v81, 0xffff0000, v72
    v_lshlrev_b32 v82, 16, v73
    v_and_b32 v83, 0xffff0000, v73
    v_lshlrev_b32 v84, 16, v74
    v_and_b32 v85, 0xffff0000, v74
    v_lshlrev_b32 v86, 16, v75
    v_and_b32 v87, 0xffff0000, v75
    v_lshlrev_b32 v88, 16, v76
    v_and_b32 v89, 0xffff0000, v76
    v_lshlrev_b32 v90, 16, v77
    v_and_b32 v91, 0xffff0000, v77
    v_lshlrev_b32 v92, 16, v78
    v_and_b32 v93, 0xffff0000, v78
    v_add_f32 v94, v80, v81
    v_add_f32 v95, v82, v83
    v_add_f32 v94, v94, v84
    v_add_f32 v95, v95, v85
    v_add_f32 v94, v94, v86
    v_add_f32 v95, v95, v87
    v_add_f32 v94, v94, v88
    v_add_f32 v95, v95, v89
    v_add_f32 v94, v94, v90
    v_add_f32 v95, v95, v91
    v_add_f32 v94, v94, v92
    v_add_f32 v95, v95, v93
    v_add_f32 v94, v94, v95
    s_nop 1
    v_add_f32_dpp v94, v94, v94 quad_perm:[1,0,3,2] row_mask:0xf bank_mask:0xf
    s_nop 1
    v_add_f32_dpp v94, v94, v94 quad_perm:[2,3,0,1] row_mask:0xf bank_mask:0xf
    s_nop 1
    v_add_f32_dpp v94, v94, v94 row_half_mirror row_mask:0xf bank_mask:0xf
    s_nop 1
    v_add_f32_dpp v94, v94, v94 row_mirror row_mask:0xf bank_mask:0xf
    v_mov_b32 v95, v94
    s_nop 1
    v_permlane16_swap_b32 v94, v95
    s_nop 1
    v_add_f32 v94, v94, v95
    v_mul_f32 v94, 0x3b124925, v94
    v_sub_f32 v96, v80, v94
    v_mul_f32 v97, v96, v96
    v_sub_f32 v96, v81, v94
    v_mul_f32 v98, v96, v96
    v_sub_f32 v96, v82, v94
    v_fmac_f32 v97, v96, v96
    v_sub_f32 v96, v83, v94
    v_fmac_f32 v98, v96, v96
    v_sub_f32 v96, v84, v94
    v_fmac_f32 v97, v96, v96
    v_sub_f32 v96, v85, v94
    v_fmac_f32 v98, v96, v96
    v_sub_f32 v96, v86, v94
    v_fmac_f32 v97, v96, v96
    v_sub_f32 v96, v87, v94
    v_fmac_f32 v98, v96, v96
    v_sub_f32 v96, v88, v94
    v_fmac_f32 v97, v96, v96
    v_sub_f32 v96, v89, v94
    v_fmac_f32 v98, v96, v96
    v_sub_f32 v96, v90, v94
    v_fmac_f32 v97, v96, v96
    v_sub_f32 v96, v91, v94
    v_fmac_f32 v98, v96, v96
    v_sub_f32 v96, v92, v94
    v_fmac_f32 v97, v96, v96
    v_sub_f32 v96, v93, v94
    v_fmac_f32 v98, v96, v96
    v_add_f32 v97, v97, v98
    s_nop 1
    v_add_f32_dpp v97, v97, v97 quad_perm:[1,0,3,2] row_mask:0xf bank_mask:0xf
    s_nop 1
    v_add_f32_dpp v97, v97, v97 quad_perm:[2,3,0,1] row_mask:0xf bank_mask:0xf
    s_nop 1
    v_add_f32_dpp v97, v97, v97 row_half_mirror row_mask:0xf bank_mask:0xf
    s_nop 1
    v_add_f32_dpp v97, v97, v97 row_mirror row_mask:0xf bank_mask:0xf
    v_mov_b32 v95, v97
    s_nop 1
    v_permlane16_swap_b32 v97, v95
    s_nop 1
    v_add_f32 v97, v97, v95
    v_mul_f32 v97, 0x3b124925, v97
    v_cvt_pk_bf16_f32 v95, v94, v97
    v_lshlrev_b32 v94, 16, v95
    v_and_b32 v97, 0xffff0000, v95
    v_add_f32 v97, 0x3727c5ac, v97
    v_cvt_pk_bf16_f32 v95, v97, v96
    v_lshlrev_b32 v97, 16, v95
    v_and_b32 v96, 0xffff0000, v95
    v_sqrt_f32 v97, v97
    s_nop 0
    v_cvt_pk_bf16_f32 v95, v97, v96
    v_lshlrev_b32 v97, 16, v95
    v_and_b32 v96, 0xffff0000, v95
    v_rcp_f32 v98, v97
    s_nop 0
    v_sub_f32 v80, v80, v94
    v_sub_f32 v81, v81, v94
    v_cvt_pk_bf16_f32 v95, v80, v81
    v_lshlrev_b32 v80, 16, v95
    v_and_b32 v81, 0xffff0000, v95
    v_mul_f32 v96, v80, v98
    v_mul_f32 v99, v81, v98
    v_fma_f32 v80, -v96, v97, v80
    v_fma_f32 v81, -v99, v97, v81
    v_fmac_f32 v96, v80, v98
    v_fmac_f32 v99, v81, v98
    v_cvt_pk_bf16_f32 v72, v96, v99
    v_sub_f32 v82, v82, v94
    v_sub_f32 v83, v83, v94
    v_cvt_pk_bf16_f32 v95, v82, v83
    v_lshlrev_b32 v82, 16, v95
    v_and_b32 v83, 0xffff0000, v95
    v_mul_f32 v96, v82, v98
    v_mul_f32 v99, v83, v98
    v_fma_f32 v82, -v96, v97, v82
    v_fma_f32 v83, -v99, v97, v83
    v_fmac_f32 v96, v82, v98
    v_fmac_f32 v99, v83, v98
    v_cvt_pk_bf16_f32 v73, v96, v99
    v_sub_f32 v84, v84, v94
    v_sub_f32 v85, v85, v94
    v_cvt_pk_bf16_f32 v95, v84, v85
    v_lshlrev_b32 v84, 16, v95
    v_and_b32 v85, 0xffff0000, v95
    v_mul_f32 v96, v84, v98
    v_mul_f32 v99, v85, v98
    v_fma_f32 v84, -v96, v97, v84
    v_fma_f32 v85, -v99, v97, v85
    v_fmac_f32 v96, v84, v98
    v_fmac_f32 v99, v85, v98
    v_cvt_pk_bf16_f32 v74, v96, v99
    v_sub_f32 v86, v86, v94
    v_sub_f32 v87, v87, v94
    v_cvt_pk_bf16_f32 v95, v86, v87
    v_lshlrev_b32 v86, 16, v95
    v_and_b32 v87, 0xffff0000, v95
    v_mul_f32 v96, v86, v98
    v_mul_f32 v99, v87, v98
    v_fma_f32 v86, -v96, v97, v86
    v_fma_f32 v87, -v99, v97, v87
    v_fmac_f32 v96, v86, v98
    v_fmac_f32 v99, v87, v98
    v_cvt_pk_bf16_f32 v75, v96, v99
    v_sub_f32 v88, v88, v94
    v_sub_f32 v89, v89, v94
    v_cvt_pk_bf16_f32 v95, v88, v89
    v_lshlrev_b32 v88, 16, v95
    v_and_b32 v89, 0xffff0000, v95
    v_mul_f32 v96, v88, v98
    v_mul_f32 v99, v89, v98
    v_fma_f32 v88, -v96, v97, v88
    v_fma_f32 v89, -v99, v97, v89
    v_fmac_f32 v96, v88, v98
    v_fmac_f32 v99, v89, v98
    v_cvt_pk_bf16_f32 v76, v96, v99
    v_sub_f32 v90, v90, v94
    v_sub_f32 v91, v91, v94
    v_cvt_pk_bf16_f32 v95, v90, v91
    v_lshlrev_b32 v90, 16, v95
    v_and_b32 v91, 0xffff0000, v95
    v_mul_f32 v96, v90, v98
    v_mul_f32 v99, v91, v98
    v_fma_f32 v90, -v96, v97, v90
    v_fma_f32 v91, -v99, v97, v91
    v_fmac_f32 v96, v90, v98
    v_fmac_f32 v99, v91, v98
    v_cvt_pk_bf16_f32 v77, v96, v99
    v_sub_f32 v92, v92, v94
    v_sub_f32 v93, v93, v94
    v_cvt_pk_bf16_f32 v95, v92, v93
    v_lshlrev_b32 v92, 16, v95
    v_and_b32 v93, 0xffff0000, v95
    v_mul_f32 v96, v92, v98
    v_mul_f32 v99, v93, v98
    v_fma_f32 v92, -v96, v97, v92
    v_fma_f32 v93, -v99, v97, v93
    v_fmac_f32 v96, v92, v98
    v_fmac_f32 v99, v93, v98
    v_cvt_pk_bf16_f32 v78, v96, v99
    ds_write_b32 v7, v72 offset:16384
    ds_write_b32 v7, v73 offset:16512
    ds_write_b32 v7, v74 offset:16640
    ds_write_b32 v7, v75 offset:16768
    ds_write_b32 v7, v76 offset:16896
    ds_write_b32 v7, v77 offset:17024
    ds_write_b32 v7, v78 offset:17152
    s_waitcnt lgkmcnt(0)
    s_barrier
    v_mov_b32 v14, 163832
    s_mov_b32 s62, 0
    s_add_u32 s26, s23, s22
    s_add_u32 s22, s22, 32768
    s_add_u32 s28, s23, s22
    s_add_u32 s22, s22, 32768
    s_mov_b32 m0, s32
    s_nop 0
    buffer_load_dwordx4 v112, s[4:7], s26 offen nt lds
    buffer_load_dwordx4 v113, s[4:7], s26 offen offset:1024 nt lds
    buffer_load_dwordx4 v114, s[4:7], s26 offen offset:2048 nt lds
    buffer_load_dwordx4 v115, s[4:7], s26 offen offset:3072 nt lds
    s_mov_b32 m0, s33
    s_nop 0
    buffer_load_dwordx4 v116, s[4:7], s26 offen nt lds
    buffer_load_dwordx4 v117, s[4:7], s26 offen offset:1024 nt lds
    buffer_load_dwordx4 v118, s[4:7], s26 offen offset:2048 nt lds
    buffer_load_dwordx4 v119, s[4:7], s26 offen offset:3072 nt lds
    s_barrier
    s_cmp_lg_u32 s62, 0
    s_cbranch_scc1 L_rpw30
    s_waitcnt vmcnt(0)
    ds_read_b32 v15, v14
    s_waitcnt lgkmcnt(0)
    v_readfirstlane_b32 s62, v15
L_rpw30:
    s_mov_b32 m0, s36
    s_nop 0
    buffer_load_dwordx4 v120, s[8:11], s26 offen nt lds
    buffer_load_dwordx4 v121, s[8:11], s26 offen offset:1024 nt lds
    buffer_load_dwordx4 v122, s[8:11], s26 offen offset:2048 nt lds
    buffer_load_dwordx4 v123, s[8:11], s26 offen offset:3072 nt lds
    s_mov_b32 m0, s37
    s_nop 0
    buffer_load_dwordx4 v124, s[8:11], s26 offen nt lds
    buffer_load_dwordx4 v125, s[8:11], s26 offen offset:1024 nt lds
    buffer_load_dwordx4 v126, s[8:11], s26 offen offset:2048 nt lds
    buffer_load_dwordx4 v127, s[8:11], s26 offen offset:3072 nt lds
    s_cmp_lg_u32 s62, 0
    s_cbranch_scc1 L_rpw31
    s_waitcnt vmcnt(0)
    ds_read_b32 v15, v14
    s_waitcnt lgkmcnt(0)
    v_readfirstlane_b32 s62, v15
L_rpw31:
    s_mov_b32 m0, s34
    s_nop 0
    buffer_load_dwordx4 v112, s[4:7], s28 offen nt lds
    buffer_load_dwordx4 v113, s[4:7], s28 offen offset:1024 nt lds
    buffer_load_dwordx4 v114, s[4:7], s28 offen offset:2048 nt lds
    buffer_load_dwordx4 v115, s[4:7], s28 offen offset:3072 nt lds
    s_mov_b32 m0, s35
    s_nop 0
    buffer_load_dwordx4 v116, s[4:7], s28 offen nt lds
    buffer_load_dwordx4 v117, s[4:7], s28 offen offset:1024 nt lds
    buffer_load_dwordx4 v118, s[4:7], s28 offen offset:2048 nt lds
    buffer_load_dwordx4 v119, s[4:7], s28 offen offset:3072 nt lds
    s_cmp_lg_u32 s62, 0
    s_cbranch_scc1 L_rpw32
    s_waitcnt vmcnt(0)
    ds_read_b32 v15, v14
    s_waitcnt lgkmcnt(0)
    v_readfirstlane_b32 s62, v15
L_rpw32:
    s_mov_b32 m0, s38
    s_nop 0
    buffer_load_dwordx4 v120, s[8:11], s28 offen nt lds
    buffer_load_dwordx4 v121, s[8:11], s28 offen offset:1024 nt lds
    buffer_load_dwordx4 v122, s[8:11], s28 offen offset:2048 nt lds
    buffer_load_dwordx4 v123, s[8:11], s28 offen offset:3072 nt lds
    s_mov_b32 m0, s39
    s_nop 0
    buffer_load_dwordx4 v124, s[8:11], s28 offen nt lds
    buffer_load_dwordx4 v125, s[8:11], s28 offen offset:1024 nt lds
    buffer_load_dwordx4 v126, s[8:11], s28 offen offset:2048 nt lds
    buffer_load_dwordx4 v127, s[8:11], s28 offen offset:3072 nt lds
    s_mov_b32 s63, 0
L_wgw3:
    s_cmp_lg_u32 s62, 0
    s_cbranch_scc1 L_wgdw3
    s_add_u32 s63, s63, 1
    s_cmp_ge_u32 s63, 2097152
    s_cbranch_scc1 L_wgdw3
    s_sleep 1
    ds_read_b32 v15, v14
    s_waitcnt lgkmcnt(0)
    v_readfirstlane_b32 s62, v15
    s_branch L_wgw3
L_wgdw3:
    s_lshr_b32 s24, s2, 2
    s_lshl_b32 s24, s24, 10
    v_and_b32 v7, 1, v3
    v_lshlrev_b32 v7, 9, v7
    v_lshl_add_u32 v7, v4, 4, v7
    buffer_load_dwordx4 v[16:19], v7, s[12:15], s24 offen offset:0 sc0 sc1
    buffer_load_dwordx4 v[20:23], v7, s[12:15], s24 offen offset:64 sc0 sc1
    buffer_load_dwordx4 v[24:27], v7, s[12:15], s24 offen offset:128 sc0 sc1
    buffer_load_dwordx4 v[28:31], v7, s[12:15], s24 offen offset:192 sc0 sc1
    buffer_load_dwordx4 v[32:35], v7, s[12:15], s24 offen offset:256 sc0 sc1
    buffer_load_dwordx4 v[36:39], v7, s[12:15], s24 offen offset:320 sc0 sc1
    buffer_load_dwordx4 v[40:43], v7, s[12:15], s24 offen offset:384 sc0 sc1
    buffer_load_dwordx4 v[44:47], v7, s[12:15], s24 offen offset:448 sc0 sc1
    s_barrier
    s_branch L_join
L_w2:
    v_mov_b32 v16, 0
    v_mov_b32 v17, 0
    v_mov_b32 v18, 0
    v_mov_b32 v19, 0
    v_lshlrev_b32 v10, 4, v2
    s_lshl_b32 s54, s2, 11
    s_add_u32 s54, s54, 131072
    buffer_store_dwordx4 v[16:19], v10, s[12:15], s54 offen sc0 sc1
    buffer_store_dwordx4 v[16:19], v10, s[12:15], s54 offen offset:1024 sc0 sc1
    s_lshl_b32 s54, s2, 4
    s_add_u32 s54, s54, 655360
    v_cmp_eq_u32 vcc, 0, v2
    s_and_saveexec_b64 s[60:61], vcc
    buffer_store_dwordx4 v[16:19], v10, s[12:15], s54 offen sc0 sc1
    s_and_b32 s54, s2, 3
    s_cmp_lg_u32 s54, 0
    s_cbranch_scc1 L_w2_noctr
    s_lshl_b32 s54, s2, 4
    s_add_u32 s54, s54, 126976
    buffer_store_dwordx4 v[16:19], v10, s[12:15], s54 offen sc0 sc1
L_w2_noctr:
    s_mov_b64 exec, s[60:61]
    buffer_load_dword v72, v7, s[16:19], 0 offen offset:0
    buffer_load_dword v73, v7, s[16:19], 0 offen offset:128
    buffer_load_dword v74, v7, s[16:19], 0 offen offset:256
    buffer_load_dword v75, v7, s[16:19], 0 offen offset:384
    buffer_load_dword v76, v7, s[16:19], 0 offen offset:512
    buffer_load_dword v77, v7, s[16:19], 0 offen offset:640
    buffer_load_dword v78, v7, s[16:19], 0 offen offset:768
    v_mov_b32 v14, 163832
    ds_write_b32 v14, v16
    s_waitcnt vmcnt(0)
    v_lshlrev_b32 v80, 16, v72
    v_and_b32 v81, 0xffff0000, v72
    v_lshlrev_b32 v82, 16, v73
    v_and_b32 v83, 0xffff0000, v73
    v_lshlrev_b32 v84, 16, v74
    v_and_b32 v85, 0xffff0000, v74
    v_lshlrev_b32 v86, 16, v75
    v_and_b32 v87, 0xffff0000, v75
    v_lshlrev_b32 v88, 16, v76
    v_and_b32 v89, 0xffff0000, v76
    v_lshlrev_b32 v90, 16, v77
    v_and_b32 v91, 0xffff0000, v77
    v_lshlrev_b32 v92, 16, v78
    v_and_b32 v93, 0xffff0000, v78
    v_add_f32 v94, v80, v81
    v_add_f32 v95, v82, v83
    v_add_f32 v94, v94, v84
    v_add_f32 v95, v95, v85
    v_add_f32 v94, v94, v86
    v_add_f32 v95, v95, v87
    v_add_f32 v94, v94, v88
    v_add_f32 v95, v95, v89
    v_add_f32 v94, v94, v90
    v_add_f32 v95, v95, v91
    v_add_f32 v94, v94, v92
    v_add_f32 v95, v95, v93
    v_add_f32 v94, v94, v95
    s_nop 1
    v_add_f32_dpp v94, v94, v94 quad_perm:[1,0,3,2] row_mask:0xf bank_mask:0xf
    s_nop 1
    v_add_f32_dpp v94, v94, v94 quad_perm:[2,3,0,1] row_mask:0xf bank_mask:0xf
    s_nop 1
    v_add_f32_dpp v94, v94, v94 row_half_mirror row_mask:0xf bank_mask:0xf
    s_nop 1
    v_add_f32_dpp v94, v94, v94 row_mirror row_mask:0xf bank_mask:0xf
    v_mov_b32 v95, v94
    s_nop 1
    v_permlane16_swap_b32 v94, v95
    s_nop 1
    v_add_f32 v94, v94, v95
    v_mul_f32 v94, 0x3b124925, v94
    v_sub_f32 v96, v80, v94
    v_mul_f32 v97, v96, v96
    v_sub_f32 v96, v81, v94
    v_mul_f32 v98, v96, v96
    v_sub_f32 v96, v82, v94
    v_fmac_f32 v97, v96, v96
    v_sub_f32 v96, v83, v94
    v_fmac_f32 v98, v96, v96
    v_sub_f32 v96, v84, v94
    v_fmac_f32 v97, v96, v96
    v_sub_f32 v96, v85, v94
    v_fmac_f32 v98, v96, v96
    v_sub_f32 v96, v86, v94
    v_fmac_f32 v97, v96, v96
    v_sub_f32 v96, v87, v94
    v_fmac_f32 v98, v96, v96
    v_sub_f32 v96, v88, v94
    v_fmac_f32 v97, v96, v96
    v_sub_f32 v96, v89, v94
    v_fmac_f32 v98, v96, v96
    v_sub_f32 v96, v90, v94
    v_fmac_f32 v97, v96, v96
    v_sub_f32 v96, v91, v94
    v_fmac_f32 v98, v96, v96
    v_sub_f32 v96, v92, v94
    v_fmac_f32 v97, v96, v96
    v_sub_f32 v96, v93, v94
    v_fmac_f32 v98, v96, v96
    v_add_f32 v97, v97, v98
    s_nop 1
    v_add_f32_dpp v97, v97, v97 quad_perm:[1,0,3,2] row_mask:0xf bank_mask:0xf
    s_nop 1
    v_add_f32_dpp v97, v97, v97 quad_perm:[2,3,0,1] row_mask:0xf bank_mask:0xf
    s_nop 1
    v_add_f32_dpp v97, v97, v97 row_half_mirror row_mask:0xf bank_mask:0xf
    s_nop 1
    v_add_f32_dpp v97, v97, v97 row_mirror row_mask:0xf bank_mask:0xf
    v_mov_b32 v95, v97
    s_nop 1
    v_permlane16_swap_b32 v97, v95
    s_nop 1
    v_add_f32 v97, v97, v95
    v_mul_f32 v97, 0x3b124925, v97
    v_cvt_pk_bf16_f32 v95, v94, v97
    v_lshlrev_b32 v94, 16, v95
    v_and_b32 v97, 0xffff0000, v95
    v_add_f32 v97, 0x3727c5ac, v97
    v_cvt_pk_bf16_f32 v95, v97, v96
    v_lshlrev_b32 v97, 16, v95
    v_and_b32 v96, 0xffff0000, v95
    v_sqrt_f32 v97, v97
    s_nop 0
    v_cvt_pk_bf16_f32 v95, v97, v96
    v_lshlrev_b32 v97, 16, v95
    v_and_b32 v96, 0xffff0000, v95
    v_rcp_f32 v98, v97
    s_nop 0
    v_sub_f32 v80, v80, v94
    v_sub_f32 v81, v81, v94
    v_cvt_pk_bf16_f32 v95, v80, v81
    v_lshlrev_b32 v80, 16, v95
    v_and_b32 v81, 0xffff0000, v95
    v_mul_f32 v96, v80, v98
    v_mul_f32 v99, v81, v98
    v_fma_f32 v80, -v96, v97, v80
    v_fma_f32 v81, -v99, v97, v81
    v_fmac_f32 v96, v80, v98
    v_fmac_f32 v99, v81, v98
    v_cvt_pk_bf16_f32 v72, v96, v99
    v_sub_f32 v82, v82, v94
    v_sub_f32 v83, v83, v94
    v_cvt_pk_bf16_f32 v95, v82, v83
    v_lshlrev_b32 v82, 16, v95
    v_and_b32 v83, 0xffff0000, v95
    v_mul_f32 v96, v82, v98
    v_mul_f32 v99, v83, v98
    v_fma_f32 v82, -v96, v97, v82
    v_fma_f32 v83, -v99, v97, v83
    v_fmac_f32 v96, v82, v98
    v_fmac_f32 v99, v83, v98
    v_cvt_pk_bf16_f32 v73, v96, v99
    v_sub_f32 v84, v84, v94
    v_sub_f32 v85, v85, v94
    v_cvt_pk_bf16_f32 v95, v84, v85
    v_lshlrev_b32 v84, 16, v95
    v_and_b32 v85, 0xffff0000, v95
    v_mul_f32 v96, v84, v98
    v_mul_f32 v99, v85, v98
    v_fma_f32 v84, -v96, v97, v84
    v_fma_f32 v85, -v99, v97, v85
    v_fmac_f32 v96, v84, v98
    v_fmac_f32 v99, v85, v98
    v_cvt_pk_bf16_f32 v74, v96, v99
    v_sub_f32 v86, v86, v94
    v_sub_f32 v87, v87, v94
    v_cvt_pk_bf16_f32 v95, v86, v87
    v_lshlrev_b32 v86, 16, v95
    v_and_b32 v87, 0xffff0000, v95
    v_mul_f32 v96, v86, v98
    v_mul_f32 v99, v87, v98
    v_fma_f32 v86, -v96, v97, v86
    v_fma_f32 v87, -v99, v97, v87
    v_fmac_f32 v96, v86, v98
    v_fmac_f32 v99, v87, v98
    v_cvt_pk_bf16_f32 v75, v96, v99
    v_sub_f32 v88, v88, v94
    v_sub_f32 v89, v89, v94
    v_cvt_pk_bf16_f32 v95, v88, v89
    v_lshlrev_b32 v88, 16, v95
    v_and_b32 v89, 0xffff0000, v95
    v_mul_f32 v96, v88, v98
    v_mul_f32 v99, v89, v98
    v_fma_f32 v88, -v96, v97, v88
    v_fma_f32 v89, -v99, v97, v89
    v_fmac_f32 v96, v88, v98
    v_fmac_f32 v99, v89, v98
    v_cvt_pk_bf16_f32 v76, v96, v99
    v_sub_f32 v90, v90, v94
    v_sub_f32 v91, v91, v94
    v_cvt_pk_bf16_f32 v95, v90, v91
    v_lshlrev_b32 v90, 16, v95
    v_and_b32 v91, 0xffff0000, v95
    v_mul_f32 v96, v90, v98
    v_mul_f32 v99, v91, v98
    v_fma_f32 v90, -v96, v97, v90
    v_fma_f32 v91, -v99, v97, v91
    v_fmac_f32 v96, v90, v98
    v_fmac_f32 v99, v91, v98
    v_cvt_pk_bf16_f32 v77, v96, v99
    v_sub_f32 v92, v92, v94
    v_sub_f32 v93, v93, v94
    v_cvt_pk_bf16_f32 v95, v92, v93
    v_lshlrev_b32 v92, 16, v95
    v_and_b32 v93, 0xffff0000, v95
    v_mul_f32 v96, v92, v98
    v_mul_f32 v99, v93, v98
    v_fma_f32 v92, -v96, v97, v92
    v_fma_f32 v93, -v99, v97, v93
    v_fmac_f32 v96, v92, v98
    v_fmac_f32 v99, v93, v98
    v_cvt_pk_bf16_f32 v78, v96, v99
    ds_write_b32 v7, v72 offset:16384
    ds_write_b32 v7, v73 offset:16512
    ds_write_b32 v7, v74 offset:16640
    ds_write_b32 v7, v75 offset:16768
    ds_write_b32 v7, v76 offset:16896
    ds_write_b32 v7, v77 offset:17024
    ds_write_b32 v7, v78 offset:17152
    s_waitcnt lgkmcnt(0)
    s_barrier
    s_add_u32 s26, s23, s22
    s_add_u32 s22, s22, 32768
    s_add_u32 s28, s23, s22
    s_add_u32 s22, s22, 32768
    s_mov_b32 m0, s32
    s_nop 0
    buffer_load_dwordx4 v112, s[4:7], s26 offen nt lds
    buffer_load_dwordx4 v113, s[4:7], s26 offen offset:1024 nt lds
    buffer_load_dwordx4 v114, s[4:7], s26 offen offset:2048 nt lds
    buffer_load_dwordx4 v115, s[4:7], s26 offen offset:3072 nt lds
    s_mov_b32 m0, s33
    s_nop 0
    buffer_load_dwordx4 v116, s[4:7], s26 offen nt lds
    buffer_load_dwordx4 v117, s[4:7], s26 offen offset:1024 nt lds
    buffer_load_dwordx4 v118, s[4:7], s26 offen offset:2048 nt lds
    buffer_load_dwordx4 v119, s[4:7], s26 offen offset:3072 nt lds
    s_barrier
    v_and_b32 v10, 7, v2
    v_lshlrev_b32 v10, 4, v10
    s_mov_b32 s54, 0
    s_sleep 64
L_poll_q:
    buffer_load_dword v11, v10, s[48:51], 0 offen offset:128 sc0 sc1
    s_waitcnt vmcnt(0)
    v_cmp_ne_u32 vcc, 32, v11
    s_cbranch_vccz L_poll_q_done
    s_add_u32 s54, s54, 1
    s_cmp_ge_u32 s54, 131072
    s_cbranch_scc1 L_poll_q_done
    s_sleep 12
    s_branch L_poll_q
L_poll_q_done:
    v_mov_b32 v15, 1
    ds_write_b32 v14, v15
    s_lshr_b32 s24, s2, 2
    s_lshl_b32 s24, s24, 10
    v_and_b32 v7, 1, v3
    v_lshlrev_b32 v7, 9, v7
    v_lshl_add_u32 v7, v4, 4, v7
    buffer_load_dwordx4 v[16:19], v7, s[12:15], s24 offen offset:0 sc0 sc1
    buffer_load_dwordx4 v[20:23], v7, s[12:15], s24 offen offset:64 sc0 sc1
    buffer_load_dwordx4 v[24:27], v7, s[12:15], s24 offen offset:128 sc0 sc1
    buffer_load_dwordx4 v[28:31], v7, s[12:15], s24 offen offset:192 sc0 sc1
    buffer_load_dwordx4 v[32:35], v7, s[12:15], s24 offen offset:256 sc0 sc1
    buffer_load_dwordx4 v[36:39], v7, s[12:15], s24 offen offset:320 sc0 sc1
    buffer_load_dwordx4 v[40:43], v7, s[12:15], s24 offen offset:384 sc0 sc1
    buffer_load_dwordx4 v[44:47], v7, s[12:15], s24 offen offset:448 sc0 sc1
    s_mov_b32 m0, s36
    s_nop 0
    buffer_load_dwordx4 v120, s[8:11], s26 offen nt lds
    buffer_load_dwordx4 v121, s[8:11], s26 offen offset:1024 nt lds
    buffer_load_dwordx4 v122, s[8:11], s26 offen offset:2048 nt lds
    buffer_load_dwordx4 v123, s[8:11], s26 offen offset:3072 nt lds
    s_mov_b32 m0, s37
    s_nop 0
    buffer_load_dwordx4 v124, s[8:11], s26 offen nt lds
    buffer_load_dwordx4 v125, s[8:11], s26 offen offset:1024 nt lds
    buffer_load_dwordx4 v126, s[8:11], s26 offen offset:2048 nt lds
    buffer_load_dwordx4 v127, s[8:11], s26 offen offset:3072 nt lds
    s_mov_b32 m0, s34
    s_nop 0
    buffer_load_dwordx4 v112, s[4:7], s28 offen nt lds
    buffer_load_dwordx4 v113, s[4:7], s28 offen offset:1024 nt lds
    buffer_load_dwordx4 v114, s[4:7], s28 offen offset:2048 nt lds
    buffer_load_dwordx4 v115, s[4:7], s28 offen offset:3072 nt lds
    s_mov_b32 m0, s35
    s_nop 0
    buffer_load_dwordx4 v116, s[4:7], s28 offen nt lds
    buffer_load_dwordx4 v117, s[4:7], s28 offen offset:1024 nt lds
    buffer_load_dwordx4 v118, s[4:7], s28 offen offset:2048 nt lds
    buffer_load_dwordx4 v119, s[4:7], s28 offen offset:3072 nt lds
    s_mov_b32 m0, s38
    s_nop 0
    buffer_load_dwordx4 v120, s[8:11], s28 offen nt lds
    buffer_load_dwordx4 v121, s[8:11], s28 offen offset:1024 nt lds
    buffer_load_dwordx4 v122, s[8:11], s28 offen offset:2048 nt lds
    buffer_load_dwordx4 v123, s[8:11], s28 offen offset:3072 nt lds
    s_mov_b32 m0, s39
    s_nop 0
    buffer_load_dwordx4 v124, s[8:11], s28 offen nt lds
    buffer_load_dwordx4 v125, s[8:11], s28 offen offset:1024 nt lds
    buffer_load_dwordx4 v126, s[8:11], s28 offen offset:2048 nt lds
    buffer_load_dwordx4 v127, s[8:11], s28 offen offset:3072 nt lds
    s_barrier
    s_branch L_join
L_w1:
    s_cmp_ge_u32 s47, 14
    s_cbranch_scc1 L_w1_noh
    v_lshrrev_b32 v105, 2, v2
    v_mul_u32_u24 v105, 7168, v105
    v_and_b32 v106, 3, v2
    v_lshl_add_u32 v105, v106, 4, v105
    s_mul_i32 s57, s46, 14
    s_add_u32 s57, s57, s47
    s_lshl_b32 s57, s57, 6
    s_add_u32 s57, s57, 65536
    v_mov_b32 v16, 0
    v_mov_b32 v17, 0
    v_mov_b32 v18, 0
    v_mov_b32 v19, 0
    v_cmp_gt_u32 vcc, 32, v2
    s_and_saveexec_b64 s[60:61], vcc
    buffer_store_dwordx4 v[16:19], v105, s[12:15], s57 offen sc0 sc1
    s_mov_b64 exec, s[60:61]
    buffer_load_dword v72, v7, s[16:19], 0 offen offset:0
    buffer_load_dword v73, v7, s[16:19], 0 offen offset:128
    buffer_load_dword v74, v7, s[16:19], 0 offen offset:256
    buffer_load_dword v75, v7, s[16:19], 0 offen offset:384
    buffer_load_dword v76, v7, s[16:19], 0 offen offset:512
    buffer_load_dword v77, v7, s[16:19], 0 offen offset:640
    buffer_load_dword v78, v7, s[16:19], 0 offen offset:768
    s_waitcnt vmcnt(0)
    v_lshlrev_b32 v80, 16, v72
    v_and_b32 v81, 0xffff0000, v72
    v_lshlrev_b32 v82, 16, v73
    v_and_b32 v83, 0xffff0000, v73
    v_lshlrev_b32 v84, 16, v74
    v_and_b32 v85, 0xffff0000, v74
    v_lshlrev_b32 v86, 16, v75
    v_and_b32 v87, 0xffff0000, v75
    v_lshlrev_b32 v88, 16, v76
    v_and_b32 v89, 0xffff0000, v76
    v_lshlrev_b32 v90, 16, v77
    v_and_b32 v91, 0xffff0000, v77
    v_lshlrev_b32 v92, 16, v78
    v_and_b32 v93, 0xffff0000, v78
    v_add_f32 v94, v80, v81
    v_add_f32 v95, v82, v83
    v_add_f32 v94, v94, v84
    v_add_f32 v95, v95, v85
    v_add_f32 v94, v94, v86
    v_add_f32 v95, v95, v87
    v_add_f32 v94, v94, v88
    v_add_f32 v95, v95, v89
    v_add_f32 v94, v94, v90
    v_add_f32 v95, v95, v91
    v_add_f32 v94, v94, v92
    v_add_f32 v95, v95, v93
    v_add_f32 v94, v94, v95
    s_nop 1
    v_add_f32_dpp v94, v94, v94 quad_perm:[1,0,3,2] row_mask:0xf bank_mask:0xf
    s_nop 1
    v_add_f32_dpp v94, v94, v94 quad_perm:[2,3,0,1] row_mask:0xf bank_mask:0xf
    s_nop 1
    v_add_f32_dpp v94, v94, v94 row_half_mirror row_mask:0xf bank_mask:0xf
    s_nop 1
    v_add_f32_dpp v94, v94, v94 row_mirror row_mask:0xf bank_mask:0xf
    v_mov_b32 v95, v94
    s_nop 1
    v_permlane16_swap_b32 v94, v95
    s_nop 1
    v_add_f32 v94, v94, v95
    v_mul_f32 v94, 0x3b124925, v94
    v_sub_f32 v96, v80, v94
    v_mul_f32 v97, v96, v96
    v_sub_f32 v96, v81, v94
    v_mul_f32 v98, v96, v96
    v_sub_f32 v96, v82, v94
    v_fmac_f32 v97, v96, v96
    v_sub_f32 v96, v83, v94
    v_fmac_f32 v98, v96, v96
    v_sub_f32 v96, v84, v94
    v_fmac_f32 v97, v96, v96
    v_sub_f32 v96, v85, v94
    v_fmac_f32 v98, v96, v96
    v_sub_f32 v96, v86, v94
    v_fmac_f32 v97, v96, v96
    v_sub_f32 v96, v87, v94
    v_fmac_f32 v98, v96, v96
    v_sub_f32 v96, v88, v94
    v_fmac_f32 v97, v96, v96
    v_sub_f32 v96, v89, v94
    v_fmac_f32 v98, v96, v96
    v_sub_f32 v96, v90, v94
    v_fmac_f32 v97, v96, v96
    v_sub_f32 v96, v91, v94
    v_fmac_f32 v98, v96, v96
    v_sub_f32 v96, v92, v94
    v_fmac_f32 v97, v96, v96
    v_sub_f32 v96, v93, v94
    v_fmac_f32 v98, v96, v96
    v_add_f32 v97, v97, v98
    s_nop 1
    v_add_f32_dpp v97, v97, v97 quad_perm:[1,0,3,2] row_mask:0xf bank_mask:0xf
    s_nop 1
    v_add_f32_dpp v97, v97, v97 quad_perm:[2,3,0,1] row_mask:0xf bank_mask:0xf
    s_nop 1
    v_add_f32_dpp v97, v97, v97 row_half_mirror row_mask:0xf bank_mask:0xf
    s_nop 1
    v_add_f32_dpp v97, v97, v97 row_mirror row_mask:0xf bank_mask:0xf
    v_mov_b32 v95, v97
    s_nop 1
    v_permlane16_swap_b32 v97, v95
    s_nop 1
    v_add_f32 v97, v97, v95
    v_mul_f32 v97, 0x3b124925, v97
    v_cvt_pk_bf16_f32 v95, v94, v97
    v_lshlrev_b32 v94, 16, v95
    v_and_b32 v97, 0xffff0000, v95
    v_add_f32 v97, 0x3727c5ac, v97
    v_cvt_pk_bf16_f32 v95, v97, v96
    v_lshlrev_b32 v97, 16, v95
    v_and_b32 v96, 0xffff0000, v95
    v_sqrt_f32 v97, v97
    s_nop 0
    v_cvt_pk_bf16_f32 v95, v97, v96
    v_lshlrev_b32 v97, 16, v95
    v_and_b32 v96, 0xffff0000, v95
    v_rcp_f32 v98, v97
    s_nop 0
    v_sub_f32 v80, v80, v94
    v_sub_f32 v81, v81, v94
    v_cvt_pk_bf16_f32 v95, v80, v81
    v_lshlrev_b32 v80, 16, v95
    v_and_b32 v81, 0xffff0000, v95
    v_mul_f32 v96, v80, v98
    v_mul_f32 v99, v81, v98
    v_fma_f32 v80, -v96, v97, v80
    v_fma_f32 v81, -v99, v97, v81
    v_fmac_f32 v96, v80, v98
    v_fmac_f32 v99, v81, v98
    v_cvt_pk_bf16_f32 v72, v96, v99
    v_sub_f32 v82, v82, v94
    v_sub_f32 v83, v83, v94
    v_cvt_pk_bf16_f32 v95, v82, v83
    v_lshlrev_b32 v82, 16, v95
    v_and_b32 v83, 0xffff0000, v95
    v_mul_f32 v96, v82, v98
    v_mul_f32 v99, v83, v98
    v_fma_f32 v82, -v96, v97, v82
    v_fma_f32 v83, -v99, v97, v83
    v_fmac_f32 v96, v82, v98
    v_fmac_f32 v99, v83, v98
    v_cvt_pk_bf16_f32 v73, v96, v99
    v_sub_f32 v84, v84, v94
    v_sub_f32 v85, v85, v94
    v_cvt_pk_bf16_f32 v95, v84, v85
    v_lshlrev_b32 v84, 16, v95
    v_and_b32 v85, 0xffff0000, v95
    v_mul_f32 v96, v84, v98
    v_mul_f32 v99, v85, v98
    v_fma_f32 v84, -v96, v97, v84
    v_fma_f32 v85, -v99, v97, v85
    v_fmac_f32 v96, v84, v98
    v_fmac_f32 v99, v85, v98
    v_cvt_pk_bf16_f32 v74, v96, v99
    v_sub_f32 v86, v86, v94
    v_sub_f32 v87, v87, v94
    v_cvt_pk_bf16_f32 v95, v86, v87
    v_lshlrev_b32 v86, 16, v95
    v_and_b32 v87, 0xffff0000, v95
    v_mul_f32 v96, v86, v98
    v_mul_f32 v99, v87, v98
    v_fma_f32 v86, -v96, v97, v86
    v_fma_f32 v87, -v99, v97, v87
    v_fmac_f32 v96, v86, v98
    v_fmac_f32 v99, v87, v98
    v_cvt_pk_bf16_f32 v75, v96, v99
    v_sub_f32 v88, v88, v94
    v_sub_f32 v89, v89, v94
    v_cvt_pk_bf16_f32 v95, v88, v89
    v_lshlrev_b32 v88, 16, v95
    v_and_b32 v89, 0xffff0000, v95
    v_mul_f32 v96, v88, v98
    v_mul_f32 v99, v89, v98
    v_fma_f32 v88, -v96, v97, v88
    v_fma_f32 v89, -v99, v97, v89
    v_fmac_f32 v96, v88, v98
    v_fmac_f32 v99, v89, v98
    v_cvt_pk_bf16_f32 v76, v96, v99
    v_sub_f32 v90, v90, v94
    v_sub_f32 v91, v91, v94
    v_cvt_pk_bf16_f32 v95, v90, v91
    v_lshlrev_b32 v90, 16, v95
    v_and_b32 v91, 0xffff0000, v95
    v_mul_f32 v96, v90, v98
    v_mul_f32 v99, v91, v98
    v_fma_f32 v90, -v96, v97, v90
    v_fma_f32 v91, -v99, v97, v91
    v_fmac_f32 v96, v90, v98
    v_fmac_f32 v99, v91, v98
    v_cvt_pk_bf16_f32 v77, v96, v99
    v_sub_f32 v92, v92, v94
    v_sub_f32 v93, v93, v94
    v_cvt_pk_bf16_f32 v95, v92, v93
    v_lshlrev_b32 v92, 16, v95
    v_and_b32 v93, 0xffff0000, v95
    v_mul_f32 v96, v92, v98
    v_mul_f32 v99, v93, v98
    v_fma_f32 v92, -v96, v97, v92
    v_fma_f32 v93, -v99, v97, v93
    v_fmac_f32 v96, v92, v98
    v_fmac_f32 v99, v93, v98
    v_cvt_pk_bf16_f32 v78, v96, v99
    ds_write_b32 v7, v72 offset:16384
    ds_write_b32 v7, v73 offset:16512
    ds_write_b32 v7, v74 offset:16640
    ds_write_b32 v7, v75 offset:16768
    ds_write_b32 v7, v76 offset:16896
    ds_write_b32 v7, v77 offset:17024
    ds_write_b32 v7, v78 offset:17152
    s_waitcnt lgkmcnt(0)
    s_barrier
    v_and_b32 v10, 7, v3
    v_mul_u32_u24 v10, 896, v10
    v_lshl_add_u32 v10, v4, 4, v10
    ds_read_b128 v[140:143], v10 offset:16384
    ds_read_b128 v[144:147], v10 offset:16448
    ds_read_b128 v[148:151], v10 offset:16512
    ds_read_b128 v[152:155], v10 offset:16576
    ds_read_b128 v[156:159], v10 offset:16640
    ds_read_b128 v[160:163], v10 offset:16704
    ds_read_b128 v[164:167], v10 offset:16768
    ds_read_b128 v[168:171], v10 offset:16832
    ds_read_b128 v[172:175], v10 offset:16896
    ds_read_b128 v[176:179], v10 offset:16960
    ds_read_b128 v[180:183], v10 offset:17024
    ds_read_b128 v[184:187], v10 offset:17088
    ds_read_b128 v[188:191], v10 offset:17152
    ds_read_b128 v[192:195], v10 offset:17216
    s_waitcnt lgkmcnt(0)
    s_barrier
    v_mov_b32 v14, 163832
    s_mov_b32 s62, 0
    s_add_u32 s26, s23, s22
    s_add_u32 s22, s22, 32768
    s_add_u32 s28, s23, s22
    s_add_u32 s22, s22, 32768
    s_mov_b32 m0, s32
    s_nop 0
    buffer_load_dwordx4 v112, s[4:7], s26 offen nt lds
    buffer_load_dwordx4 v113, s[4:7], s26 offen offset:1024 nt lds
    buffer_load_dwordx4 v114, s[4:7], s26 offen offset:2048 nt lds
    buffer_load_dwordx4 v115, s[4:7], s26 offen offset:3072 nt lds
    s_mov_b32 m0, s33
    s_nop 0
    buffer_load_dwordx4 v116, s[4:7], s26 offen nt lds
    buffer_load_dwordx4 v117, s[4:7], s26 offen offset:1024 nt lds
    buffer_load_dwordx4 v118, s[4:7], s26 offen offset:2048 nt lds
    buffer_load_dwordx4 v119, s[4:7], s26 offen offset:3072 nt lds
    s_cmp_lg_u32 s62, 0
    s_cbranch_scc1 L_rpw1a0
    s_waitcnt vmcnt(0)
    ds_read_b32 v15, v14
    s_waitcnt lgkmcnt(0)
    v_readfirstlane_b32 s62, v15
L_rpw1a0:
    s_mov_b32 m0, s36
    s_nop 0
    buffer_load_dwordx4 v120, s[8:11], s26 offen nt lds
    buffer_load_dwordx4 v121, s[8:11], s26 offen offset:1024 nt lds
    buffer_load_dwordx4 v122, s[8:11], s26 offen offset:2048 nt lds
    buffer_load_dwordx4 v123, s[8:11], s26 offen offset:3072 nt lds
    s_mov_b32 m0, s37
    s_nop 0
    buffer_load_dwordx4 v124, s[8:11], s26 offen nt lds
    buffer_load_dwordx4 v125, s[8:11], s26 offen offset:1024 nt lds
    buffer_load_dwordx4 v126, s[8:11], s26 offen offset:2048 nt lds
    buffer_load_dwordx4 v127, s[8:11], s26 offen offset:3072 nt lds
    s_cmp_lg_u32 s62, 0
    s_cbranch_scc1 L_rpw1a1
    s_waitcnt vmcnt(0)
    ds_read_b32 v15, v14
    s_waitcnt lgkmcnt(0)
    v_readfirstlane_b32 s62, v15
L_rpw1a1:
    s_mov_b32 m0, s34
    s_nop 0
    buffer_load_dwordx4 v112, s[4:7], s28 offen nt lds
    buffer_load_dwordx4 v113, s[4:7], s28 offen offset:1024 nt lds
    buffer_load_dwordx4 v114, s[4:7], s28 offen offset:2048 nt lds
    buffer_load_dwordx4 v115, s[4:7], s28 offen offset:3072 nt lds
    s_mov_b32 m0, s35
    s_nop 0
    buffer_load_dwordx4 v116, s[4:7], s28 offen nt lds
    buffer_load_dwordx4 v117, s[4:7], s28 offen offset:1024 nt lds
    buffer_load_dwordx4 v118, s[4:7], s28 offen offset:2048 nt lds
    buffer_load_dwordx4 v119, s[4:7], s28 offen offset:3072 nt lds
    s_cmp_lg_u32 s62, 0
    s_cbranch_scc1 L_rpw1a2
    s_waitcnt vmcnt(0)
    ds_read_b32 v15, v14
    s_waitcnt lgkmcnt(0)
    v_readfirstlane_b32 s62, v15
L_rpw1a2:
    s_mov_b32 m0, s38
    s_nop 0
    buffer_load_dwordx4 v120, s[8:11], s28 offen nt lds
    buffer_load_dwordx4 v121, s[8:11], s28 offen offset:1024 nt lds
    buffer_load_dwordx4 v122, s[8:11], s28 offen offset:2048 nt lds
    buffer_load_dwordx4 v123, s[8:11], s28 offen offset:3072 nt lds
    s_mov_b32 m0, s39
    s_nop 0
    buffer_load_dwordx4 v124, s[8:11], s28 offen nt lds
    buffer_load_dwordx4 v125, s[8:11], s28 offen offset:1024 nt lds
    buffer_load_dwordx4 v126, s[8:11], s28 offen offset:2048 nt lds
    buffer_load_dwordx4 v127, s[8:11], s28 offen offset:3072 nt lds
    s_mov_b32 s92, s76
    s_and_b32 s93, s77, 0xffff
    s_mov_b32 s94, 0x188000
    s_mov_b32 s95, 0x00020000
    s_mul_i32 s54, s46, 14
    s_add_u32 s54, s54, s47
    s_lshl_b32 s55, s54, 5
    v_lshrrev_b32 v10, 1, v2
    v_mul_u32_u24 v10, 3584, v10
    v_and_b32 v11, 1, v2
    v_lshl_add_u32 v10, v11, 4, v10
    s_mov_b32 s56, s55
    s_mov_b32 m0, 131072
    s_nop 0
    buffer_load_dwordx4 v10, s[92:95], s56 offen lds
    s_add_u32 s56, s56, 114688
    s_mov_b32 m0, 132096
    s_nop 0
    buffer_load_dwordx4 v10, s[92:95], s56 offen lds
    s_add_u32 s56, s56, 114688
    s_mov_b32 m0, 133120
    s_nop 0
    buffer_load_dwordx4 v10, s[92:95], s56 offen lds
    s_add_u32 s56, s56, 114688
    s_mov_b32 m0, 134144
    s_nop 0
    buffer_load_dwordx4 v10, s[92:95], s56 offen lds
    s_add_u32 s56, s56, 114688
    s_mov_b32 m0, 135168
    s_nop 0
    buffer_load_dwordx4 v10, s[92:95], s56 offen lds
    s_add_u32 s56, s56, 114688
    s_mov_b32 m0, 136192
    s_nop 0
    buffer_load_dwordx4 v10, s[92:95], s56 offen lds
    s_add_u32 s56, s56, 114688
    s_mov_b32 m0, 137216
    s_nop 0
    buffer_load_dwordx4 v10, s[92:95], s56 offen lds
    s_add_u32 s56, s56, 114688
    s_mov_b32 m0, 138240
    s_nop 0
    buffer_load_dwordx4 v10, s[92:95], s56 offen lds
    s_add_u32 s56, s56, 114688
    s_mov_b32 m0, 139264
    s_nop 0
    buffer_load_dwordx4 v10, s[92:95], s56 offen lds
    s_add_u32 s56, s56, 114688
    s_mov_b32 m0, 140288
    s_nop 0
    buffer_load_dwordx4 v10, s[92:95], s56 offen lds
    s_add_u32 s56, s56, 114688
    s_mov_b32 m0, 141312
    s_nop 0
    buffer_load_dwordx4 v10, s[92:95], s56 offen lds
    s_add_u32 s56, s56, 114688
    s_mov_b32 m0, 142336
    s_nop 0
    buffer_load_dwordx4 v10, s[92:95], s56 offen lds
    s_add_u32 s56, s56, 114688
    s_mov_b32 m0, 143360
    s_nop 0
    buffer_load_dwordx4 v10, s[92:95], s56 offen lds
    s_add_u32 s56, s56, 114688
    s_mov_b32 m0, 144384
    s_nop 0
    buffer_load_dwordx4 v10, s[92:95], s56 offen lds
    s_mov_b32 s28, s78
    s_and_b32 s29, s79, 0xffff
    s_mov_b32 s30, 0xe00
    s_mov_b32 s31, 0x00020000
    v_lshlrev_b32 v11, 1, v3
    buffer_load_ushort v104, v11, s[28:31], s55 offen
    s_mov_b32 s63, 0
L_wgw1a:
    s_cmp_lg_u32 s62, 0
    s_cbranch_scc1 L_wgdw1a
    s_add_u32 s63, s63, 1
    s_cmp_ge_u32 s63, 2097152
    s_cbranch_scc1 L_wgdw1a
    s_sleep 1
    ds_read_b32 v15, v14
    s_waitcnt lgkmcnt(0)
    v_readfirstlane_b32 s62, v15
    s_branch L_wgw1a
L_wgdw1a:
    s_lshr_b32 s24, s2, 2
    s_lshl_b32 s24, s24, 10
    v_and_b32 v7, 1, v3
    v_lshlrev_b32 v7, 9, v7
    v_lshl_add_u32 v7, v4, 4, v7
    buffer_load_dwordx4 v[16:19], v7, s[12:15], s24 offen offset:0 sc0 sc1
    buffer_load_dwordx4 v[20:23], v7, s[12:15], s24 offen offset:64 sc0 sc1
    buffer_load_dwordx4 v[24:27], v7, s[12:15], s24 offen offset:128 sc0 sc1
    buffer_load_dwordx4 v[28:31], v7, s[12:15], s24 offen offset:192 sc0 sc1
    buffer_load_dwordx4 v[32:35], v7, s[12:15], s24 offen offset:256 sc0 sc1
    buffer_load_dwordx4 v[36:39], v7, s[12:15], s24 offen offset:320 sc0 sc1
    buffer_load_dwordx4 v[40:43], v7, s[12:15], s24 offen offset:384 sc0 sc1
    buffer_load_dwordx4 v[44:47], v7, s[12:15], s24 offen offset:448 sc0 sc1
    s_barrier
    v_lshrrev_b32 v11, 2, v3
    v_lshl_add_u32 v11, v4, 3, v11
    v_lshlrev_b32 v11, 5, v11
    v_and_b32 v12, 3, v3
    v_lshl_add_u32 v11, v12, 3, v11
    v_add_u32 v11, 131072, v11
    s_waitcnt vmcnt(8)
    ds_read_b64_tr_b16 v[48:49], v11 offset:0
    ds_read_b64_tr_b16 v[50:51], v11 offset:128
    ds_read_b64_tr_b16 v[52:53], v11 offset:1024
    ds_read_b64_tr_b16 v[54:55], v11 offset:1152
    ds_read_b64_tr_b16 v[56:57], v11 offset:2048
    ds_read_b64_tr_b16 v[58:59], v11 offset:2176
    ds_read_b64_tr_b16 v[60:61], v11 offset:3072
    ds_read_b64_tr_b16 v[62:63], v11 offset:3200
    ds_read_b64_tr_b16 v[64:65], v11 offset:4096
    ds_read_b64_tr_b16 v[66:67], v11 offset:4224
    ds_read_b64_tr_b16 v[68:69], v11 offset:5120
    ds_read_b64_tr_b16 v[70:71], v11 offset:5248
    ds_read_b64_tr_b16 v[72:73], v11 offset:6144
    ds_read_b64_tr_b16 v[74:75], v11 offset:6272
    ds_read_b64_tr_b16 v[76:77], v11 offset:7168
    ds_read_b64_tr_b16 v[78:79], v11 offset:7296
    ds_read_b64_tr_b16 v[80:81], v11 offset:8192
    ds_read_b64_tr_b16 v[82:83], v11 offset:8320
    ds_read_b64_tr_b16 v[84:85], v11 offset:9216
    ds_read_b64_tr_b16 v[86:87], v11 offset:9344
    ds_read_b64_tr_b16 v[88:89], v11 offset:10240
    ds_read_b64_tr_b16 v[90:91], v11 offset:10368
    ds_read_b64_tr_b16 v[92:93], v11 offset:11264
    ds_read_b64_tr_b16 v[94:95], v11 offset:11392
    ds_read_b64_tr_b16 v[96:97], v11 offset:12288
    ds_read_b64_tr_b16 v[98:99], v11 offset:12416
    ds_read_b64_tr_b16 v[100:101], v11 offset:13312
    ds_read_b64_tr_b16 v[102:103], v11 offset:13440
    s_waitcnt lgkmcnt(0)
    v_mfma_f32_16x16x32_bf16 v[196:199], v[140:143], v[48:51], 0
    v_mfma_f32_16x16x32_bf16 v[196:199], v[144:147], v[52:55], v[196:199]
    v_mfma_f32_16x16x32_bf16 v[196:199], v[148:151], v[56:59], v[196:199]
    v_mfma_f32_16x16x32_bf16 v[196:199], v[152:155], v[60:63], v[196:199]
    v_mfma_f32_16x16x32_bf16 v[196:199], v[156:159], v[64:67], v[196:199]
    v_mfma_f32_16x16x32_bf16 v[196:199], v[160:163], v[68:71], v[196:199]
    v_mfma_f32_16x16x32_bf16 v[196:199], v[164:167], v[72:75], v[196:199]
    v_mfma_f32_16x16x32_bf16 v[196:199], v[168:171], v[76:79], v[196:199]
    v_mfma_f32_16x16x32_bf16 v[196:199], v[172:175], v[80:83], v[196:199]
    v_mfma_f32_16x16x32_bf16 v[196:199], v[176:179], v[84:87], v[196:199]
    v_mfma_f32_16x16x32_bf16 v[196:199], v[180:183], v[88:91], v[196:199]
    v_mfma_f32_16x16x32_bf16 v[196:199], v[184:187], v[92:95], v[196:199]
    v_mfma_f32_16x16x32_bf16 v[196:199], v[188:191], v[96:99], v[196:199]
    v_mfma_f32_16x16x32_bf16 v[196:199], v[192:195], v[100:103], v[196:199]
    v_lshlrev_b32 v10, 8, v4
    v_lshl_add_u32 v10, v3, 2, v10
    v_add_u32 v10, 131072, v10
    v_lshlrev_b32 v13, 4, v2
    v_add_u32 v13, 131072, v13
    s_nop 7
    v_lshlrev_b32 v104, 16, v104
    v_cvt_pk_bf16_f32 v11, v196, v197
    v_lshlrev_b32 v196, 16, v11
    v_and_b32 v197, 0xffff0000, v11
    v_cvt_pk_bf16_f32 v11, v198, v199
    v_lshlrev_b32 v198, 16, v11
    v_and_b32 v199, 0xffff0000, v11
    v_add_f32 v196, v196, v104
    v_add_f32 v197, v197, v104
    v_add_f32 v198, v198, v104
    v_add_f32 v199, v199, v104
    v_cvt_pk_bf16_f32 v11, v196, v197
    v_lshlrev_b32 v196, 16, v11
    v_and_b32 v197, 0xffff0000, v11
    v_cvt_pk_bf16_f32 v11, v198, v199
    v_lshlrev_b32 v198, 16, v11
    v_and_b32 v199, 0xffff0000, v11
    v_mul_f32 v12, v196, v196
    v_mul_f32 v12, 0x3d372713, v12
    v_fma_f32 v12, v12, v196, v196
    v_mul_f32 v12, 0xc0135761, v12
    v_exp_f32 v12, v12
    s_nop 0
    v_add_f32 v12, 1.0, v12
    v_rcp_f32 v12, v12
    s_nop 0
    v_mul_f32 v196, v196, v12
    v_mul_f32 v12, v197, v197
    v_mul_f32 v12, 0x3d372713, v12
    v_fma_f32 v12, v12, v197, v197
    v_mul_f32 v12, 0xc0135761, v12
    v_exp_f32 v12, v12
    s_nop 0
    v_add_f32 v12, 1.0, v12
    v_rcp_f32 v12, v12
    s_nop 0
    v_mul_f32 v197, v197, v12
    v_mul_f32 v12, v198, v198
    v_mul_f32 v12, 0x3d372713, v12
    v_fma_f32 v12, v12, v198, v198
    v_mul_f32 v12, 0xc0135761, v12
    v_exp_f32 v12, v12
    s_nop 0
    v_add_f32 v12, 1.0, v12
    v_rcp_f32 v12, v12
    s_nop 0
    v_mul_f32 v198, v198, v12
    v_mul_f32 v12, v199, v199
    v_mul_f32 v12, 0x3d372713, v12
    v_fma_f32 v12, v12, v199, v199
    v_mul_f32 v12, 0xc0135761, v12
    v_exp_f32 v12, v12
    s_nop 0
    v_add_f32 v12, 1.0, v12
    v_rcp_f32 v12, v12
    s_nop 0
    v_mul_f32 v199, v199, v12
    v_cvt_pk_bf16_f32 v11, v196, v197
    v_lshlrev_b32 v196, 16, v11
    v_and_b32 v197, 0xffff0000, v11
    v_cvt_pk_bf16_f32 v11, v198, v199
    v_lshlrev_b32 v198, 16, v11
    v_and_b32 v199, 0xffff0000, v11
    v_or_b32 v196, 1, v196
    v_or_b32 v197, 1, v197
    v_or_b32 v198, 1, v198
    v_or_b32 v199, 1, v199
    v_cmp_gt_u32 vcc, 32, v2
    s_and_saveexec_b64 s[60:61], vcc
    ds_write_b32 v10, v196 offset:16384
    ds_write_b32 v10, v197 offset:16448
    ds_write_b32 v10, v198 offset:16512
    ds_write_b32 v10, v199 offset:16576
    s_waitcnt lgkmcnt(0)
    ds_read_b128 v[196:199], v13 offset:16384
    s_waitcnt lgkmcnt(0)
    buffer_store_dwordx4 v[196:199], v105, s[12:15], s57 offen sc0 sc1
    s_mov_b64 exec, s[60:61]
    s_waitcnt vmcnt(1)
    s_cmp_ge_u32 s2, 161
    s_cbranch_scc1 L_rd_donea
    v_lshrrev_b32 v10, 3, v2
    v_mul_u32_u24 v10, 896, v10
    v_and_b32 v11, 7, v2
    v_lshl_add_u32 v10, v11, 4, v10
    s_lshl_b32 s54, s45, 7
    s_cmp_ge_u32 s44, 16
    s_cbranch_scc1 L_rd_ffna
    s_mov_b32 s92, s72
    s_and_b32 s93, s73, 0xffff
    s_mov_b32 s94, 0x380000
    s_mov_b32 s95, 0x00020000
    s_mul_i32 s55, s44, 229376
    s_add_u32 s54, s54, s55
    s_mov_b32 m0, 131072
    s_nop 0
    buffer_load_dwordx4 v10, s[92:95], s54 offen lds
    s_add_u32 s54, s54, 7168
    s_mov_b32 m0, 132096
    s_nop 0
    buffer_load_dwordx4 v10, s[92:95], s54 offen lds
    s_add_u32 s54, s54, 7168
    s_mov_b32 m0, 133120
    s_nop 0
    buffer_load_dwordx4 v10, s[92:95], s54 offen lds
    s_add_u32 s54, s54, 7168
    s_mov_b32 m0, 134144
    s_nop 0
    buffer_load_dwordx4 v10, s[92:95], s54 offen lds
    s_add_u32 s54, s54, 7168
    s_mov_b32 m0, 135168
    s_nop 0
    buffer_load_dwordx4 v10, s[92:95], s54 offen lds
    s_add_u32 s54, s54, 7168
    s_mov_b32 m0, 136192
    s_nop 0
    buffer_load_dwordx4 v10, s[92:95], s54 offen lds
    s_add_u32 s54, s54, 7168
    s_mov_b32 m0, 137216
    s_nop 0
    buffer_load_dwordx4 v10, s[92:95], s54 offen lds
    s_add_u32 s54, s54, 7168
    s_mov_b32 m0, 138240
    s_nop 0
    buffer_load_dwordx4 v10, s[92:95], s54 offen lds
    s_add_u32 s54, s54, 7168
    s_mov_b32 m0, 139264
    s_nop 0
    buffer_load_dwordx4 v10, s[92:95], s54 offen lds
    s_add_u32 s54, s54, 7168
    s_mov_b32 m0, 140288
    s_nop 0
    buffer_load_dwordx4 v10, s[92:95], s54 offen lds
    s_add_u32 s54, s54, 7168
    s_mov_b32 m0, 141312
    s_nop 0
    buffer_load_dwordx4 v10, s[92:95], s54 offen lds
    s_add_u32 s54, s54, 7168
    s_mov_b32 m0, 142336
    s_nop 0
    buffer_load_dwordx4 v10, s[92:95], s54 offen lds
    s_add_u32 s54, s54, 7168
    s_mov_b32 m0, 143360
    s_nop 0
    buffer_load_dwordx4 v10, s[92:95], s54 offen lds
    s_add_u32 s54, s54, 7168
    s_mov_b32 m0, 144384
    s_nop 0
    buffer_load_dwordx4 v10, s[92:95], s54 offen lds
    s_add_u32 s54, s54, 7168
    s_mov_b32 m0, 145408
    s_nop 0
    buffer_load_dwordx4 v10, s[92:95], s54 offen lds
    s_add_u32 s54, s54, 7168
    s_mov_b32 m0, 146432
    s_nop 0
    buffer_load_dwordx4 v10, s[92:95], s54 offen lds
    s_add_u32 s54, s54, 7168
    s_mov_b32 m0, 147456
    s_nop 0
    buffer_load_dwordx4 v10, s[92:95], s54 offen lds
    s_add_u32 s54, s54, 7168
    s_mov_b32 m0, 148480
    s_nop 0
    buffer_load_dwordx4 v10, s[92:95], s54 offen lds
    s_add_u32 s54, s54, 7168
    s_mov_b32 m0, 149504
    s_nop 0
    buffer_load_dwordx4 v10, s[92:95], s54 offen lds
    s_add_u32 s54, s54, 7168
    s_mov_b32 m0, 150528
    s_nop 0
    buffer_load_dwordx4 v10, s[92:95], s54 offen lds
    s_add_u32 s54, s54, 7168
    s_mov_b32 m0, 151552
    s_nop 0
    buffer_load_dwordx4 v10, s[92:95], s54 offen lds
    s_add_u32 s54, s54, 7168
    s_mov_b32 m0, 152576
    s_nop 0
    buffer_load_dwordx4 v10, s[92:95], s54 offen lds
    s_add_u32 s54, s54, 7168
    s_mov_b32 m0, 153600
    s_nop 0
    buffer_load_dwordx4 v10, s[92:95], s54 offen lds
    s_add_u32 s54, s54, 7168
    s_mov_b32 m0, 154624
    s_nop 0
    buffer_load_dwordx4 v10, s[92:95], s54 offen lds
    s_add_u32 s54, s54, 7168
    s_mov_b32 m0, 155648
    s_nop 0
    buffer_load_dwordx4 v10, s[92:95], s54 offen lds
    s_add_u32 s54, s54, 7168
    s_mov_b32 m0, 156672
    s_nop 0
    buffer_load_dwordx4 v10, s[92:95], s54 offen lds
    s_add_u32 s54, s54, 7168
    s_mov_b32 m0, 157696
    s_nop 0
    buffer_load_dwordx4 v10, s[92:95], s54 offen lds
    s_add_u32 s54, s54, 7168
    s_mov_b32 m0, 158720
    s_nop 0
    buffer_load_dwordx4 v10, s[92:95], s54 offen lds
    s_add_u32 s54, s54, 7168
    s_mov_b32 m0, 159744
    s_nop 0
    buffer_load_dwordx4 v10, s[92:95], s54 offen lds
    s_add_u32 s54, s54, 7168
    s_mov_b32 m0, 160768
    s_nop 0
    buffer_load_dwordx4 v10, s[92:95], s54 offen lds
    s_add_u32 s54, s54, 7168
    s_mov_b32 m0, 161792
    s_nop 0
    buffer_load_dwordx4 v10, s[92:95], s54 offen lds
    s_add_u32 s54, s54, 7168
    s_mov_b32 m0, 162816
    s_nop 0
    buffer_load_dwordx4 v10, s[92:95], s54 offen lds
    s_branch L_rd_donea
L_rd_ffna:
    s_mov_b32 s92, s80
    s_and_b32 s93, s81, 0xffff
    s_mov_b32 s94, 0x188000
    s_mov_b32 s95, 0x00020000
    s_sub_u32 s55, s44, 16
    s_mul_i32 s55, s55, 229376
    s_add_u32 s54, s54, s55
    s_mov_b32 m0, 131072
    s_nop 0
    buffer_load_dwordx4 v10, s[92:95], s54 offen lds
    s_add_u32 s54, s54, 7168
    s_mov_b32 m0, 132096
    s_nop 0
    buffer_load_dwordx4 v10, s[92:95], s54 offen lds
    s_add_u32 s54, s54, 7168
    s_mov_b32 m0, 133120
    s_nop 0
    buffer_load_dwordx4 v10, s[92:95], s54 offen lds
    s_add_u32 s54, s54, 7168
    s_mov_b32 m0, 134144
    s_nop 0
    buffer_load_dwordx4 v10, s[92:95], s54 offen lds
    s_add_u32 s54, s54, 7168
    s_mov_b32 m0, 135168
    s_nop 0
    buffer_load_dwordx4 v10, s[92:95], s54 offen lds
    s_add_u32 s54, s54, 7168
    s_mov_b32 m0, 136192
    s_nop 0
    buffer_load_dwordx4 v10, s[92:95], s54 offen lds
    s_add_u32 s54, s54, 7168
    s_mov_b32 m0, 137216
    s_nop 0
    buffer_load_dwordx4 v10, s[92:95], s54 offen lds
    s_add_u32 s54, s54, 7168
    s_mov_b32 m0, 138240
    s_nop 0
    buffer_load_dwordx4 v10, s[92:95], s54 offen lds
    s_add_u32 s54, s54, 7168
    s_mov_b32 m0, 139264
    s_nop 0
    buffer_load_dwordx4 v10, s[92:95], s54 offen lds
    s_add_u32 s54, s54, 7168
    s_mov_b32 m0, 140288
    s_nop 0
    buffer_load_dwordx4 v10, s[92:95], s54 offen lds
    s_add_u32 s54, s54, 7168
    s_mov_b32 m0, 141312
    s_nop 0
    buffer_load_dwordx4 v10, s[92:95], s54 offen lds
    s_add_u32 s54, s54, 7168
    s_mov_b32 m0, 142336
    s_nop 0
    buffer_load_dwordx4 v10, s[92:95], s54 offen lds
    s_add_u32 s54, s54, 7168
    s_mov_b32 m0, 143360
    s_nop 0
    buffer_load_dwordx4 v10, s[92:95], s54 offen lds
    s_add_u32 s54, s54, 7168
    s_mov_b32 m0, 144384
    s_nop 0
    buffer_load_dwordx4 v10, s[92:95], s54 offen lds
    s_add_u32 s54, s54, 7168
    s_mov_b32 m0, 145408
    s_nop 0
    buffer_load_dwordx4 v10, s[92:95], s54 offen lds
    s_add_u32 s54, s54, 7168
    s_mov_b32 m0, 146432
    s_nop 0
    buffer_load_dwordx4 v10, s[92:95], s54 offen lds
    s_add_u32 s54, s54, 7168
    s_mov_b32 m0, 147456
    s_nop 0
    buffer_load_dwordx4 v10, s[92:95], s54 offen lds
    s_add_u32 s54, s54, 7168
    s_mov_b32 m0, 148480
    s_nop 0
    buffer_load_dwordx4 v10, s[92:95], s54 offen lds
    s_add_u32 s54, s54, 7168
    s_mov_b32 m0, 149504
    s_nop 0
    buffer_load_dwordx4 v10, s[92:95], s54 offen lds
    s_add_u32 s54, s54, 7168
    s_mov_b32 m0, 150528
    s_nop 0
    buffer_load_dwordx4 v10, s[92:95], s54 offen lds
    s_add_u32 s54, s54, 7168
    s_mov_b32 m0, 151552
    s_nop 0
    buffer_load_dwordx4 v10, s[92:95], s54 offen lds
    s_add_u32 s54, s54, 7168
    s_mov_b32 m0, 152576
    s_nop 0
    buffer_load_dwordx4 v10, s[92:95], s54 offen lds
    s_add_u32 s54, s54, 7168
    s_mov_b32 m0, 153600
    s_nop 0
    buffer_load_dwordx4 v10, s[92:95], s54 offen lds
    s_add_u32 s54, s54, 7168
    s_mov_b32 m0, 154624
    s_nop 0
    buffer_load_dwordx4 v10, s[92:95], s54 offen lds
    s_add_u32 s54, s54, 7168
    s_mov_b32 m0, 155648
    s_nop 0
    buffer_load_dwordx4 v10, s[92:95], s54 offen lds
    s_add_u32 s54, s54, 7168
    s_mov_b32 m0, 156672
    s_nop 0
    buffer_load_dwordx4 v10, s[92:95], s54 offen lds
    s_add_u32 s54, s54, 7168
    s_mov_b32 m0, 157696
    s_nop 0
    buffer_load_dwordx4 v10, s[92:95], s54 offen lds
    s_add_u32 s54, s54, 7168
    s_mov_b32 m0, 158720
    s_nop 0
    buffer_load_dwordx4 v10, s[92:95], s54 offen lds
    s_add_u32 s54, s54, 7168
    s_mov_b32 m0, 159744
    s_nop 0
    buffer_load_dwordx4 v10, s[92:95], s54 offen lds
    s_add_u32 s54, s54, 7168
    s_mov_b32 m0, 160768
    s_nop 0
    buffer_load_dwordx4 v10, s[92:95], s54 offen lds
    s_add_u32 s54, s54, 7168
    s_mov_b32 m0, 161792
    s_nop 0
    buffer_load_dwordx4 v10, s[92:95], s54 offen lds
    s_add_u32 s54, s54, 7168
    s_mov_b32 m0, 162816
    s_nop 0
    buffer_load_dwordx4 v10, s[92:95], s54 offen lds
L_rd_donea:
    s_branch L_join2
L_w1_noh:
    buffer_load_dword v72, v7, s[16:19], 0 offen offset:0
    buffer_load_dword v73, v7, s[16:19], 0 offen offset:128
    buffer_load_dword v74, v7, s[16:19], 0 offen offset:256
    buffer_load_dword v75, v7, s[16:19], 0 offen offset:384
    buffer_load_dword v76, v7, s[16:19], 0 offen offset:512
    buffer_load_dword v77, v7, s[16:19], 0 offen offset:640
    buffer_load_dword v78, v7, s[16:19], 0 offen offset:768
    s_waitcnt vmcnt(0)
    v_lshlrev_b32 v80, 16, v72
    v_and_b32 v81, 0xffff0000, v72
    v_lshlrev_b32 v82, 16, v73
    v_and_b32 v83, 0xffff0000, v73
    v_lshlrev_b32 v84, 16, v74
    v_and_b32 v85, 0xffff0000, v74
    v_lshlrev_b32 v86, 16, v75
    v_and_b32 v87, 0xffff0000, v75
    v_lshlrev_b32 v88, 16, v76
    v_and_b32 v89, 0xffff0000, v76
    v_lshlrev_b32 v90, 16, v77
    v_and_b32 v91, 0xffff0000, v77
    v_lshlrev_b32 v92, 16, v78
    v_and_b32 v93, 0xffff0000, v78
    v_add_f32 v94, v80, v81
    v_add_f32 v95, v82, v83
    v_add_f32 v94, v94, v84
    v_add_f32 v95, v95, v85
    v_add_f32 v94, v94, v86
    v_add_f32 v95, v95, v87
    v_add_f32 v94, v94, v88
    v_add_f32 v95, v95, v89
    v_add_f32 v94, v94, v90
    v_add_f32 v95, v95, v91
    v_add_f32 v94, v94, v92
    v_add_f32 v95, v95, v93
    v_add_f32 v94, v94, v95
    s_nop 1
    v_add_f32_dpp v94, v94, v94 quad_perm:[1,0,3,2] row_mask:0xf bank_mask:0xf
    s_nop 1
    v_add_f32_dpp v94, v94, v94 quad_perm:[2,3,0,1] row_mask:0xf bank_mask:0xf
    s_nop 1
    v_add_f32_dpp v94, v94, v94 row_half_mirror row_mask:0xf bank_mask:0xf
    s_nop 1
    v_add_f32_dpp v94, v94, v94 row_mirror row_mask:0xf bank_mask:0xf
    v_mov_b32 v95, v94
    s_nop 1
    v_permlane16_swap_b32 v94, v95
    s_nop 1
    v_add_f32 v94, v94, v95
    v_mul_f32 v94, 0x3b124925, v94
    v_sub_f32 v96, v80, v94
    v_mul_f32 v97, v96, v96
    v_sub_f32 v96, v81, v94
    v_mul_f32 v98, v96, v96
    v_sub_f32 v96, v82, v94
    v_fmac_f32 v97, v96, v96
    v_sub_f32 v96, v83, v94
    v_fmac_f32 v98, v96, v96
    v_sub_f32 v96, v84, v94
    v_fmac_f32 v97, v96, v96
    v_sub_f32 v96, v85, v94
    v_fmac_f32 v98, v96, v96
    v_sub_f32 v96, v86, v94
    v_fmac_f32 v97, v96, v96
    v_sub_f32 v96, v87, v94
    v_fmac_f32 v98, v96, v96
    v_sub_f32 v96, v88, v94
    v_fmac_f32 v97, v96, v96
    v_sub_f32 v96, v89, v94
    v_fmac_f32 v98, v96, v96
    v_sub_f32 v96, v90, v94
    v_fmac_f32 v97, v96, v96
    v_sub_f32 v96, v91, v94
    v_fmac_f32 v98, v96, v96
    v_sub_f32 v96, v92, v94
    v_fmac_f32 v97, v96, v96
    v_sub_f32 v96, v93, v94
    v_fmac_f32 v98, v96, v96
    v_add_f32 v97, v97, v98
    s_nop 1
    v_add_f32_dpp v97, v97, v97 quad_perm:[1,0,3,2] row_mask:0xf bank_mask:0xf
    s_nop 1
    v_add_f32_dpp v97, v97, v97 quad_perm:[2,3,0,1] row_mask:0xf bank_mask:0xf
    s_nop 1
    v_add_f32_dpp v97, v97, v97 row_half_mirror row_mask:0xf bank_mask:0xf
    s_nop 1
    v_add_f32_dpp v97, v97, v97 row_mirror row_mask:0xf bank_mask:0xf
    v_mov_b32 v95, v97
    s_nop 1
    v_permlane16_swap_b32 v97, v95
    s_nop 1
    v_add_f32 v97, v97, v95
    v_mul_f32 v97, 0x3b124925, v97
    v_cvt_pk_bf16_f32 v95, v94, v97
    v_lshlrev_b32 v94, 16, v95
    v_and_b32 v97, 0xffff0000, v95
    v_add_f32 v97, 0x3727c5ac, v97
    v_cvt_pk_bf16_f32 v95, v97, v96
    v_lshlrev_b32 v97, 16, v95
    v_and_b32 v96, 0xffff0000, v95
    v_sqrt_f32 v97, v97
    s_nop 0
    v_cvt_pk_bf16_f32 v95, v97, v96
    v_lshlrev_b32 v97, 16, v95
    v_and_b32 v96, 0xffff0000, v95
    v_rcp_f32 v98, v97
    s_nop 0
    v_sub_f32 v80, v80, v94
    v_sub_f32 v81, v81, v94
    v_cvt_pk_bf16_f32 v95, v80, v81
    v_lshlrev_b32 v80, 16, v95
    v_and_b32 v81, 0xffff0000, v95
    v_mul_f32 v96, v80, v98
    v_mul_f32 v99, v81, v98
    v_fma_f32 v80, -v96, v97, v80
    v_fma_f32 v81, -v99, v97, v81
    v_fmac_f32 v96, v80, v98
    v_fmac_f32 v99, v81, v98
    v_cvt_pk_bf16_f32 v72, v96, v99
    v_sub_f32 v82, v82, v94
    v_sub_f32 v83, v83, v94
    v_cvt_pk_bf16_f32 v95, v82, v83
    v_lshlrev_b32 v82, 16, v95
    v_and_b32 v83, 0xffff0000, v95
    v_mul_f32 v96, v82, v98
    v_mul_f32 v99, v83, v98
    v_fma_f32 v82, -v96, v97, v82
    v_fma_f32 v83, -v99, v97, v83
    v_fmac_f32 v96, v82, v98
    v_fmac_f32 v99, v83, v98
    v_cvt_pk_bf16_f32 v73, v96, v99
    v_sub_f32 v84, v84, v94
    v_sub_f32 v85, v85, v94
    v_cvt_pk_bf16_f32 v95, v84, v85
    v_lshlrev_b32 v84, 16, v95
    v_and_b32 v85, 0xffff0000, v95
    v_mul_f32 v96, v84, v98
    v_mul_f32 v99, v85, v98
    v_fma_f32 v84, -v96, v97, v84
    v_fma_f32 v85, -v99, v97, v85
    v_fmac_f32 v96, v84, v98
    v_fmac_f32 v99, v85, v98
    v_cvt_pk_bf16_f32 v74, v96, v99
    v_sub_f32 v86, v86, v94
    v_sub_f32 v87, v87, v94
    v_cvt_pk_bf16_f32 v95, v86, v87
    v_lshlrev_b32 v86, 16, v95
    v_and_b32 v87, 0xffff0000, v95
    v_mul_f32 v96, v86, v98
    v_mul_f32 v99, v87, v98
    v_fma_f32 v86, -v96, v97, v86
    v_fma_f32 v87, -v99, v97, v87
    v_fmac_f32 v96, v86, v98
    v_fmac_f32 v99, v87, v98
    v_cvt_pk_bf16_f32 v75, v96, v99
    v_sub_f32 v88, v88, v94
    v_sub_f32 v89, v89, v94
    v_cvt_pk_bf16_f32 v95, v88, v89
    v_lshlrev_b32 v88, 16, v95
    v_and_b32 v89, 0xffff0000, v95
    v_mul_f32 v96, v88, v98
    v_mul_f32 v99, v89, v98
    v_fma_f32 v88, -v96, v97, v88
    v_fma_f32 v89, -v99, v97, v89
    v_fmac_f32 v96, v88, v98
    v_fmac_f32 v99, v89, v98
    v_cvt_pk_bf16_f32 v76, v96, v99
    v_sub_f32 v90, v90, v94
    v_sub_f32 v91, v91, v94
    v_cvt_pk_bf16_f32 v95, v90, v91
    v_lshlrev_b32 v90, 16, v95
    v_and_b32 v91, 0xffff0000, v95
    v_mul_f32 v96, v90, v98
    v_mul_f32 v99, v91, v98
    v_fma_f32 v90, -v96, v97, v90
    v_fma_f32 v91, -v99, v97, v91
    v_fmac_f32 v96, v90, v98
    v_fmac_f32 v99, v91, v98
    v_cvt_pk_bf16_f32 v77, v96, v99
    v_sub_f32 v92, v92, v94
    v_sub_f32 v93, v93, v94
    v_cvt_pk_bf16_f32 v95, v92, v93
    v_lshlrev_b32 v92, 16, v95
    v_and_b32 v93, 0xffff0000, v95
    v_mul_f32 v96, v92, v98
    v_mul_f32 v99, v93, v98
    v_fma_f32 v92, -v96, v97, v92
    v_fma_f32 v93, -v99, v97, v93
    v_fmac_f32 v96, v92, v98
    v_fmac_f32 v99, v93, v98
    v_cvt_pk_bf16_f32 v78, v96, v99
    ds_write_b32 v7, v72 offset:16384
    ds_write_b32 v7, v73 offset:16512
    ds_write_b32 v7, v74 offset:16640
    ds_write_b32 v7, v75 offset:16768
    ds_write_b32 v7, v76 offset:16896
    ds_write_b32 v7, v77 offset:17024
    ds_write_b32 v7, v78 offset:17152
    s_waitcnt lgkmcnt(0)
    s_barrier
    s_barrier
    v_mov_b32 v14, 163832
    s_mov_b32 s62, 0
    s_add_u32 s26, s23, s22
    s_add_u32 s22, s22, 32768
    s_add_u32 s28, s23, s22
    s_add_u32 s22, s22, 32768
    s_mov_b32 m0, s32
    s_nop 0
    buffer_load_dwordx4 v112, s[4:7], s26 offen nt lds
    buffer_load_dwordx4 v113, s[4:7], s26 offen offset:1024 nt lds
    buffer_load_dwordx4 v114, s[4:7], s26 offen offset:2048 nt lds
    buffer_load_dwordx4 v115, s[4:7], s26 offen offset:3072 nt lds
    s_mov_b32 m0, s33
    s_nop 0
    buffer_load_dwordx4 v116, s[4:7], s26 offen nt lds
    buffer_load_dwordx4 v117, s[4:7], s26 offen offset:1024 nt lds
    buffer_load_dwordx4 v118, s[4:7], s26 offen offset:2048 nt lds
    buffer_load_dwordx4 v119, s[4:7], s26 offen offset:3072 nt lds
    s_cmp_lg_u32 s62, 0
    s_cbranch_scc1 L_rpw1b0
    s_waitcnt vmcnt(0)
    ds_read_b32 v15, v14
    s_waitcnt lgkmcnt(0)
    v_readfirstlane_b32 s62, v15
L_rpw1b0:
    s_mov_b32 m0, s36
    s_nop 0
    buffer_load_dwordx4 v120, s[8:11], s26 offen nt lds
    buffer_load_dwordx4 v121, s[8:11], s26 offen offset:1024 nt lds
    buffer_load_dwordx4 v122, s[8:11], s26 offen offset:2048 nt lds
    buffer_load_dwordx4 v123, s[8:11], s26 offen offset:3072 nt lds
    s_mov_b32 m0, s37
    s_nop 0
    buffer_load_dwordx4 v124, s[8:11], s26 offen nt lds
    buffer_load_dwordx4 v125, s[8:11], s26 offen offset:1024 nt lds
    buffer_load_dwordx4 v126, s[8:11], s26 offen offset:2048 nt lds
    buffer_load_dwordx4 v127, s[8:11], s26 offen offset:3072 nt lds
    s_cmp_lg_u32 s62, 0
    s_cbranch_scc1 L_rpw1b1
    s_waitcnt vmcnt(0)
    ds_read_b32 v15, v14
    s_waitcnt lgkmcnt(0)
    v_readfirstlane_b32 s62, v15
L_rpw1b1:
    s_mov_b32 m0, s34
    s_nop 0
    buffer_load_dwordx4 v112, s[4:7], s28 offen nt lds
    buffer_load_dwordx4 v113, s[4:7], s28 offen offset:1024 nt lds
    buffer_load_dwordx4 v114, s[4:7], s28 offen offset:2048 nt lds
    buffer_load_dwordx4 v115, s[4:7], s28 offen offset:3072 nt lds
    s_mov_b32 m0, s35
    s_nop 0
    buffer_load_dwordx4 v116, s[4:7], s28 offen nt lds
    buffer_load_dwordx4 v117, s[4:7], s28 offen offset:1024 nt lds
    buffer_load_dwordx4 v118, s[4:7], s28 offen offset:2048 nt lds
    buffer_load_dwordx4 v119, s[4:7], s28 offen offset:3072 nt lds
    s_cmp_lg_u32 s62, 0
    s_cbranch_scc1 L_rpw1b2
    s_waitcnt vmcnt(0)
    ds_read_b32 v15, v14
    s_waitcnt lgkmcnt(0)
    v_readfirstlane_b32 s62, v15
L_rpw1b2:
    s_mov_b32 m0, s38
    s_nop 0
    buffer_load_dwordx4 v120, s[8:11], s28 offen nt lds
    buffer_load_dwordx4 v121, s[8:11], s28 offen offset:1024 nt lds
    buffer_load_dwordx4 v122, s[8:11], s28 offen offset:2048 nt lds
    buffer_load_dwordx4 v123, s[8:11], s28 offen offset:3072 nt lds
    s_mov_b32 m0, s39
    s_nop 0
    buffer_load_dwordx4 v124, s[8:11], s28 offen nt lds
    buffer_load_dwordx4 v125, s[8:11], s28 offen offset:1024 nt lds
    buffer_load_dwordx4 v126, s[8:11], s28 offen offset:2048 nt lds
    buffer_load_dwordx4 v127, s[8:11], s28 offen offset:3072 nt lds
    s_mov_b32 s63, 0
L_wgw1b:
    s_cmp_lg_u32 s62, 0
    s_cbranch_scc1 L_wgdw1b
    s_add_u32 s63, s63, 1
    s_cmp_ge_u32 s63, 2097152
    s_cbranch_scc1 L_wgdw1b
    s_sleep 1
    ds_read_b32 v15, v14
    s_waitcnt lgkmcnt(0)
    v_readfirstlane_b32 s62, v15
    s_branch L_wgw1b
L_wgdw1b:
    s_lshr_b32 s24, s2, 2
    s_lshl_b32 s24, s24, 10
    v_and_b32 v7, 1, v3
    v_lshlrev_b32 v7, 9, v7
    v_lshl_add_u32 v7, v4, 4, v7
    buffer_load_dwordx4 v[16:19], v7, s[12:15], s24 offen offset:0 sc0 sc1
    buffer_load_dwordx4 v[20:23], v7, s[12:15], s24 offen offset:64 sc0 sc1
    buffer_load_dwordx4 v[24:27], v7, s[12:15], s24 offen offset:128 sc0 sc1
    buffer_load_dwordx4 v[28:31], v7, s[12:15], s24 offen offset:192 sc0 sc1
    buffer_load_dwordx4 v[32:35], v7, s[12:15], s24 offen offset:256 sc0 sc1
    buffer_load_dwordx4 v[36:39], v7, s[12:15], s24 offen offset:320 sc0 sc1
    buffer_load_dwordx4 v[40:43], v7, s[12:15], s24 offen offset:384 sc0 sc1
    buffer_load_dwordx4 v[44:47], v7, s[12:15], s24 offen offset:448 sc0 sc1
    s_barrier
    s_waitcnt vmcnt(0)
    s_cmp_ge_u32 s2, 161
    s_cbranch_scc1 L_rd_doneb
    v_lshrrev_b32 v10, 3, v2
    v_mul_u32_u24 v10, 896, v10
    v_and_b32 v11, 7, v2
    v_lshl_add_u32 v10, v11, 4, v10
    s_lshl_b32 s54, s45, 7
    s_cmp_ge_u32 s44, 16
    s_cbranch_scc1 L_rd_ffnb
    s_mov_b32 s92, s72
    s_and_b32 s93, s73, 0xffff
    s_mov_b32 s94, 0x380000
    s_mov_b32 s95, 0x00020000
    s_mul_i32 s55, s44, 229376
    s_add_u32 s54, s54, s55
    s_mov_b32 m0, 131072
    s_nop 0
    buffer_load_dwordx4 v10, s[92:95], s54 offen lds
    s_add_u32 s54, s54, 7168
    s_mov_b32 m0, 132096
    s_nop 0
    buffer_load_dwordx4 v10, s[92:95], s54 offen lds
    s_add_u32 s54, s54, 7168
    s_mov_b32 m0, 133120
    s_nop 0
    buffer_load_dwordx4 v10, s[92:95], s54 offen lds
    s_add_u32 s54, s54, 7168
    s_mov_b32 m0, 134144
    s_nop 0
    buffer_load_dwordx4 v10, s[92:95], s54 offen lds
    s_add_u32 s54, s54, 7168
    s_mov_b32 m0, 135168
    s_nop 0
    buffer_load_dwordx4 v10, s[92:95], s54 offen lds
    s_add_u32 s54, s54, 7168
    s_mov_b32 m0, 136192
    s_nop 0
    buffer_load_dwordx4 v10, s[92:95], s54 offen lds
    s_add_u32 s54, s54, 7168
    s_mov_b32 m0, 137216
    s_nop 0
    buffer_load_dwordx4 v10, s[92:95], s54 offen lds
    s_add_u32 s54, s54, 7168
    s_mov_b32 m0, 138240
    s_nop 0
    buffer_load_dwordx4 v10, s[92:95], s54 offen lds
    s_add_u32 s54, s54, 7168
    s_mov_b32 m0, 139264
    s_nop 0
    buffer_load_dwordx4 v10, s[92:95], s54 offen lds
    s_add_u32 s54, s54, 7168
    s_mov_b32 m0, 140288
    s_nop 0
    buffer_load_dwordx4 v10, s[92:95], s54 offen lds
    s_add_u32 s54, s54, 7168
    s_mov_b32 m0, 141312
    s_nop 0
    buffer_load_dwordx4 v10, s[92:95], s54 offen lds
    s_add_u32 s54, s54, 7168
    s_mov_b32 m0, 142336
    s_nop 0
    buffer_load_dwordx4 v10, s[92:95], s54 offen lds
    s_add_u32 s54, s54, 7168
    s_mov_b32 m0, 143360
    s_nop 0
    buffer_load_dwordx4 v10, s[92:95], s54 offen lds
    s_add_u32 s54, s54, 7168
    s_mov_b32 m0, 144384
    s_nop 0
    buffer_load_dwordx4 v10, s[92:95], s54 offen lds
    s_add_u32 s54, s54, 7168
    s_mov_b32 m0, 145408
    s_nop 0
    buffer_load_dwordx4 v10, s[92:95], s54 offen lds
    s_add_u32 s54, s54, 7168
    s_mov_b32 m0, 146432
    s_nop 0
    buffer_load_dwordx4 v10, s[92:95], s54 offen lds
    s_add_u32 s54, s54, 7168
    s_mov_b32 m0, 147456
    s_nop 0
    buffer_load_dwordx4 v10, s[92:95], s54 offen lds
    s_add_u32 s54, s54, 7168
    s_mov_b32 m0, 148480
    s_nop 0
    buffer_load_dwordx4 v10, s[92:95], s54 offen lds
    s_add_u32 s54, s54, 7168
    s_mov_b32 m0, 149504
    s_nop 0
    buffer_load_dwordx4 v10, s[92:95], s54 offen lds
    s_add_u32 s54, s54, 7168
    s_mov_b32 m0, 150528
    s_nop 0
    buffer_load_dwordx4 v10, s[92:95], s54 offen lds
    s_add_u32 s54, s54, 7168
    s_mov_b32 m0, 151552
    s_nop 0
    buffer_load_dwordx4 v10, s[92:95], s54 offen lds
    s_add_u32 s54, s54, 7168
    s_mov_b32 m0, 152576
    s_nop 0
    buffer_load_dwordx4 v10, s[92:95], s54 offen lds
    s_add_u32 s54, s54, 7168
    s_mov_b32 m0, 153600
    s_nop 0
    buffer_load_dwordx4 v10, s[92:95], s54 offen lds
    s_add_u32 s54, s54, 7168
    s_mov_b32 m0, 154624
    s_nop 0
    buffer_load_dwordx4 v10, s[92:95], s54 offen lds
    s_add_u32 s54, s54, 7168
    s_mov_b32 m0, 155648
    s_nop 0
    buffer_load_dwordx4 v10, s[92:95], s54 offen lds
    s_add_u32 s54, s54, 7168
    s_mov_b32 m0, 156672
    s_nop 0
    buffer_load_dwordx4 v10, s[92:95], s54 offen lds
    s_add_u32 s54, s54, 7168
    s_mov_b32 m0, 157696
    s_nop 0
    buffer_load_dwordx4 v10, s[92:95], s54 offen lds
    s_add_u32 s54, s54, 7168
    s_mov_b32 m0, 158720
    s_nop 0
    buffer_load_dwordx4 v10, s[92:95], s54 offen lds
    s_add_u32 s54, s54, 7168
    s_mov_b32 m0, 159744
    s_nop 0
    buffer_load_dwordx4 v10, s[92:95], s54 offen lds
    s_add_u32 s54, s54, 7168
    s_mov_b32 m0, 160768
    s_nop 0
    buffer_load_dwordx4 v10, s[92:95], s54 offen lds
    s_add_u32 s54, s54, 7168
    s_mov_b32 m0, 161792
    s_nop 0
    buffer_load_dwordx4 v10, s[92:95], s54 offen lds
    s_add_u32 s54, s54, 7168
    s_mov_b32 m0, 162816
    s_nop 0
    buffer_load_dwordx4 v10, s[92:95], s54 offen lds
    s_branch L_rd_doneb
L_rd_ffnb:
    s_mov_b32 s92, s80
    s_and_b32 s93, s81, 0xffff
    s_mov_b32 s94, 0x188000
    s_mov_b32 s95, 0x00020000
    s_sub_u32 s55, s44, 16
    s_mul_i32 s55, s55, 229376
    s_add_u32 s54, s54, s55
    s_mov_b32 m0, 131072
    s_nop 0
    buffer_load_dwordx4 v10, s[92:95], s54 offen lds
    s_add_u32 s54, s54, 7168
    s_mov_b32 m0, 132096
    s_nop 0
    buffer_load_dwordx4 v10, s[92:95], s54 offen lds
    s_add_u32 s54, s54, 7168
    s_mov_b32 m0, 133120
    s_nop 0
    buffer_load_dwordx4 v10, s[92:95], s54 offen lds
    s_add_u32 s54, s54, 7168
    s_mov_b32 m0, 134144
    s_nop 0
    buffer_load_dwordx4 v10, s[92:95], s54 offen lds
    s_add_u32 s54, s54, 7168
    s_mov_b32 m0, 135168
    s_nop 0
    buffer_load_dwordx4 v10, s[92:95], s54 offen lds
    s_add_u32 s54, s54, 7168
    s_mov_b32 m0, 136192
    s_nop 0
    buffer_load_dwordx4 v10, s[92:95], s54 offen lds
    s_add_u32 s54, s54, 7168
    s_mov_b32 m0, 137216
    s_nop 0
    buffer_load_dwordx4 v10, s[92:95], s54 offen lds
    s_add_u32 s54, s54, 7168
    s_mov_b32 m0, 138240
    s_nop 0
    buffer_load_dwordx4 v10, s[92:95], s54 offen lds
    s_add_u32 s54, s54, 7168
    s_mov_b32 m0, 139264
    s_nop 0
    buffer_load_dwordx4 v10, s[92:95], s54 offen lds
    s_add_u32 s54, s54, 7168
    s_mov_b32 m0, 140288
    s_nop 0
    buffer_load_dwordx4 v10, s[92:95], s54 offen lds
    s_add_u32 s54, s54, 7168
    s_mov_b32 m0, 141312
    s_nop 0
    buffer_load_dwordx4 v10, s[92:95], s54 offen lds
    s_add_u32 s54, s54, 7168
    s_mov_b32 m0, 142336
    s_nop 0
    buffer_load_dwordx4 v10, s[92:95], s54 offen lds
    s_add_u32 s54, s54, 7168
    s_mov_b32 m0, 143360
    s_nop 0
    buffer_load_dwordx4 v10, s[92:95], s54 offen lds
    s_add_u32 s54, s54, 7168
    s_mov_b32 m0, 144384
    s_nop 0
    buffer_load_dwordx4 v10, s[92:95], s54 offen lds
    s_add_u32 s54, s54, 7168
    s_mov_b32 m0, 145408
    s_nop 0
    buffer_load_dwordx4 v10, s[92:95], s54 offen lds
    s_add_u32 s54, s54, 7168
    s_mov_b32 m0, 146432
    s_nop 0
    buffer_load_dwordx4 v10, s[92:95], s54 offen lds
    s_add_u32 s54, s54, 7168
    s_mov_b32 m0, 147456
    s_nop 0
    buffer_load_dwordx4 v10, s[92:95], s54 offen lds
    s_add_u32 s54, s54, 7168
    s_mov_b32 m0, 148480
    s_nop 0
    buffer_load_dwordx4 v10, s[92:95], s54 offen lds
    s_add_u32 s54, s54, 7168
    s_mov_b32 m0, 149504
    s_nop 0
    buffer_load_dwordx4 v10, s[92:95], s54 offen lds
    s_add_u32 s54, s54, 7168
    s_mov_b32 m0, 150528
    s_nop 0
    buffer_load_dwordx4 v10, s[92:95], s54 offen lds
    s_add_u32 s54, s54, 7168
    s_mov_b32 m0, 151552
    s_nop 0
    buffer_load_dwordx4 v10, s[92:95], s54 offen lds
    s_add_u32 s54, s54, 7168
    s_mov_b32 m0, 152576
    s_nop 0
    buffer_load_dwordx4 v10, s[92:95], s54 offen lds
    s_add_u32 s54, s54, 7168
    s_mov_b32 m0, 153600
    s_nop 0
    buffer_load_dwordx4 v10, s[92:95], s54 offen lds
    s_add_u32 s54, s54, 7168
    s_mov_b32 m0, 154624
    s_nop 0
    buffer_load_dwordx4 v10, s[92:95], s54 offen lds
    s_add_u32 s54, s54, 7168
    s_mov_b32 m0, 155648
    s_nop 0
    buffer_load_dwordx4 v10, s[92:95], s54 offen lds
    s_add_u32 s54, s54, 7168
    s_mov_b32 m0, 156672
    s_nop 0
    buffer_load_dwordx4 v10, s[92:95], s54 offen lds
    s_add_u32 s54, s54, 7168
    s_mov_b32 m0, 157696
    s_nop 0
    buffer_load_dwordx4 v10, s[92:95], s54 offen lds
    s_add_u32 s54, s54, 7168
    s_mov_b32 m0, 158720
    s_nop 0
    buffer_load_dwordx4 v10, s[92:95], s54 offen lds
    s_add_u32 s54, s54, 7168
    s_mov_b32 m0, 159744
    s_nop 0
    buffer_load_dwordx4 v10, s[92:95], s54 offen lds
    s_add_u32 s54, s54, 7168
    s_mov_b32 m0, 160768
    s_nop 0
    buffer_load_dwordx4 v10, s[92:95], s54 offen lds
    s_add_u32 s54, s54, 7168
    s_mov_b32 m0, 161792
    s_nop 0
    buffer_load_dwordx4 v10, s[92:95], s54 offen lds
    s_add_u32 s54, s54, 7168
    s_mov_b32 m0, 162816
    s_nop 0
    buffer_load_dwordx4 v10, s[92:95], s54 offen lds
L_rd_doneb:
    s_branch L_join2
L_w0:
    buffer_load_dword v72, v7, s[16:19], 0 offen offset:0
    buffer_load_dword v73, v7, s[16:19], 0 offen offset:128
    buffer_load_dword v74, v7, s[16:19], 0 offen offset:256
    buffer_load_dword v75, v7, s[16:19], 0 offen offset:384
    buffer_load_dword v76, v7, s[16:19], 0 offen offset:512
    buffer_load_dword v77, v7, s[16:19], 0 offen offset:640
    buffer_load_dword v78, v7, s[16:19], 0 offen offset:768
    s_mov_b32 s92, s70
    s_and_b32 s93, s71, 0xffff
    s_mov_b32 s94, 0x380000
    s_mov_b32 s95, 0x00020000
    s_lshl_b32 s54, s46, 5
    s_add_u32 s54, s54, s47
    s_lshl_b32 s55, s54, 5
    v_lshrrev_b32 v10, 1, v2
    v_mul_u32_u24 v10, 8192, v10
    v_and_b32 v11, 1, v2
    v_lshl_add_u32 v10, v11, 4, v10
    s_mov_b32 s56, s55
    s_mov_b32 m0, 0
    s_nop 0
    buffer_load_dwordx4 v10, s[92:95], s56 offen lds
    s_add_u32 s56, s56, 262144
    s_mov_b32 m0, 1024
    s_nop 0
    buffer_load_dwordx4 v10, s[92:95], s56 offen lds
    s_add_u32 s56, s56, 262144
    s_mov_b32 m0, 2048
    s_nop 0
    buffer_load_dwordx4 v10, s[92:95], s56 offen lds
    s_add_u32 s56, s56, 262144
    s_mov_b32 m0, 3072
    s_nop 0
    buffer_load_dwordx4 v10, s[92:95], s56 offen lds
    s_add_u32 s56, s56, 262144
    s_mov_b32 m0, 4096
    s_nop 0
    buffer_load_dwordx4 v10, s[92:95], s56 offen lds
    s_add_u32 s56, s56, 262144
    s_mov_b32 m0, 5120
    s_nop 0
    buffer_load_dwordx4 v10, s[92:95], s56 offen lds
    s_add_u32 s56, s56, 262144
    s_mov_b32 m0, 6144
    s_nop 0
    buffer_load_dwordx4 v10, s[92:95], s56 offen lds
    s_add_u32 s56, s56, 262144
    s_mov_b32 m0, 7168
    s_nop 0
    buffer_load_dwordx4 v10, s[92:95], s56 offen lds
    s_add_u32 s56, s56, 262144
    s_mov_b32 m0, 8192
    s_nop 0
    buffer_load_dwordx4 v10, s[92:95], s56 offen lds
    s_add_u32 s56, s56, 262144
    s_mov_b32 m0, 9216
    s_nop 0
    buffer_load_dwordx4 v10, s[92:95], s56 offen lds
    s_add_u32 s56, s56, 262144
    s_mov_b32 m0, 10240
    s_nop 0
    buffer_load_dwordx4 v10, s[92:95], s56 offen lds
    s_add_u32 s56, s56, 262144
    s_mov_b32 m0, 11264
    s_nop 0
    buffer_load_dwordx4 v10, s[92:95], s56 offen lds
    s_add_u32 s56, s56, 262144
    s_mov_b32 m0, 12288
    s_nop 0
    buffer_load_dwordx4 v10, s[92:95], s56 offen lds
    s_add_u32 s56, s56, 262144
    s_mov_b32 m0, 13312
    s_nop 0
    buffer_load_dwordx4 v10, s[92:95], s56 offen lds
    s_waitcnt vmcnt(14)
    v_lshlrev_b32 v80, 16, v72
    v_and_b32 v81, 0xffff0000, v72
    v_lshlrev_b32 v82, 16, v73
    v_and_b32 v83, 0xffff0000, v73
    v_lshlrev_b32 v84, 16, v74
    v_and_b32 v85, 0xffff0000, v74
    v_lshlrev_b32 v86, 16, v75
    v_and_b32 v87, 0xffff0000, v75
    v_lshlrev_b32 v88, 16, v76
    v_and_b32 v89, 0xffff0000, v76
    v_lshlrev_b32 v90, 16, v77
    v_and_b32 v91, 0xffff0000, v77
    v_lshlrev_b32 v92, 16, v78
    v_and_b32 v93, 0xffff0000, v78
    v_add_f32 v94, v80, v81
    v_add_f32 v95, v82, v83
    v_add_f32 v94, v94, v84
    v_add_f32 v95, v95, v85
    v_add_f32 v94, v94, v86
    v_add_f32 v95, v95, v87
    v_add_f32 v94, v94, v88
    v_add_f32 v95, v95, v89
    v_add_f32 v94, v94, v90
    v_add_f32 v95, v95, v91
    v_add_f32 v94, v94, v92
    v_add_f32 v95, v95, v93
    v_add_f32 v94, v94, v95
    s_nop 1
    v_add_f32_dpp v94, v94, v94 quad_perm:[1,0,3,2] row_mask:0xf bank_mask:0xf
    s_nop 1
    v_add_f32_dpp v94, v94, v94 quad_perm:[2,3,0,1] row_mask:0xf bank_mask:0xf
    s_nop 1
    v_add_f32_dpp v94, v94, v94 row_half_mirror row_mask:0xf bank_mask:0xf
    s_nop 1
    v_add_f32_dpp v94, v94, v94 row_mirror row_mask:0xf bank_mask:0xf
    v_mov_b32 v95, v94
    s_nop 1
    v_permlane16_swap_b32 v94, v95
    s_nop 1
    v_add_f32 v94, v94, v95
    v_mul_f32 v94, 0x3b124925, v94
    v_sub_f32 v96, v80, v94
    v_mul_f32 v97, v96, v96
    v_sub_f32 v96, v81, v94
    v_mul_f32 v98, v96, v96
    v_sub_f32 v96, v82, v94
    v_fmac_f32 v97, v96, v96
    v_sub_f32 v96, v83, v94
    v_fmac_f32 v98, v96, v96
    v_sub_f32 v96, v84, v94
    v_fmac_f32 v97, v96, v96
    v_sub_f32 v96, v85, v94
    v_fmac_f32 v98, v96, v96
    v_sub_f32 v96, v86, v94
    v_fmac_f32 v97, v96, v96
    v_sub_f32 v96, v87, v94
    v_fmac_f32 v98, v96, v96
    v_sub_f32 v96, v88, v94
    v_fmac_f32 v97, v96, v96
    v_sub_f32 v96, v89, v94
    v_fmac_f32 v98, v96, v96
    v_sub_f32 v96, v90, v94
    v_fmac_f32 v97, v96, v96
    v_sub_f32 v96, v91, v94
    v_fmac_f32 v98, v96, v96
    v_sub_f32 v96, v92, v94
    v_fmac_f32 v97, v96, v96
    v_sub_f32 v96, v93, v94
    v_fmac_f32 v98, v96, v96
    v_add_f32 v97, v97, v98
    s_nop 1
    v_add_f32_dpp v97, v97, v97 quad_perm:[1,0,3,2] row_mask:0xf bank_mask:0xf
    s_nop 1
    v_add_f32_dpp v97, v97, v97 quad_perm:[2,3,0,1] row_mask:0xf bank_mask:0xf
    s_nop 1
    v_add_f32_dpp v97, v97, v97 row_half_mirror row_mask:0xf bank_mask:0xf
    s_nop 1
    v_add_f32_dpp v97, v97, v97 row_mirror row_mask:0xf bank_mask:0xf
    v_mov_b32 v95, v97
    s_nop 1
    v_permlane16_swap_b32 v97, v95
    s_nop 1
    v_add_f32 v97, v97, v95
    v_mul_f32 v97, 0x3b124925, v97
    v_cvt_pk_bf16_f32 v95, v94, v97
    v_lshlrev_b32 v94, 16, v95
    v_and_b32 v97, 0xffff0000, v95
    v_add_f32 v97, 0x3727c5ac, v97
    v_cvt_pk_bf16_f32 v95, v97, v96
    v_lshlrev_b32 v97, 16, v95
    v_and_b32 v96, 0xffff0000, v95
    v_sqrt_f32 v97, v97
    s_nop 0
    v_cvt_pk_bf16_f32 v95, v97, v96
    v_lshlrev_b32 v97, 16, v95
    v_and_b32 v96, 0xffff0000, v95
    v_rcp_f32 v98, v97
    s_nop 0
    v_sub_f32 v80, v80, v94
    v_sub_f32 v81, v81, v94
    v_cvt_pk_bf16_f32 v95, v80, v81
    v_lshlrev_b32 v80, 16, v95
    v_and_b32 v81, 0xffff0000, v95
    v_mul_f32 v96, v80, v98
    v_mul_f32 v99, v81, v98
    v_fma_f32 v80, -v96, v97, v80
    v_fma_f32 v81, -v99, v97, v81
    v_fmac_f32 v96, v80, v98
    v_fmac_f32 v99, v81, v98
    v_cvt_pk_bf16_f32 v72, v96, v99
    v_sub_f32 v82, v82, v94
    v_sub_f32 v83, v83, v94
    v_cvt_pk_bf16_f32 v95, v82, v83
    v_lshlrev_b32 v82, 16, v95
    v_and_b32 v83, 0xffff0000, v95
    v_mul_f32 v96, v82, v98
    v_mul_f32 v99, v83, v98
    v_fma_f32 v82, -v96, v97, v82
    v_fma_f32 v83, -v99, v97, v83
    v_fmac_f32 v96, v82, v98
    v_fmac_f32 v99, v83, v98
    v_cvt_pk_bf16_f32 v73, v96, v99
    v_sub_f32 v84, v84, v94
    v_sub_f32 v85, v85, v94
    v_cvt_pk_bf16_f32 v95, v84, v85
    v_lshlrev_b32 v84, 16, v95
    v_and_b32 v85, 0xffff0000, v95
    v_mul_f32 v96, v84, v98
    v_mul_f32 v99, v85, v98
    v_fma_f32 v84, -v96, v97, v84
    v_fma_f32 v85, -v99, v97, v85
    v_fmac_f32 v96, v84, v98
    v_fmac_f32 v99, v85, v98
    v_cvt_pk_bf16_f32 v74, v96, v99
    v_sub_f32 v86, v86, v94
    v_sub_f32 v87, v87, v94
    v_cvt_pk_bf16_f32 v95, v86, v87
    v_lshlrev_b32 v86, 16, v95
    v_and_b32 v87, 0xffff0000, v95
    v_mul_f32 v96, v86, v98
    v_mul_f32 v99, v87, v98
    v_fma_f32 v86, -v96, v97, v86
    v_fma_f32 v87, -v99, v97, v87
    v_fmac_f32 v96, v86, v98
    v_fmac_f32 v99, v87, v98
    v_cvt_pk_bf16_f32 v75, v96, v99
    v_sub_f32 v88, v88, v94
    v_sub_f32 v89, v89, v94
    v_cvt_pk_bf16_f32 v95, v88, v89
    v_lshlrev_b32 v88, 16, v95
    v_and_b32 v89, 0xffff0000, v95
    v_mul_f32 v96, v88, v98
    v_mul_f32 v99, v89, v98
    v_fma_f32 v88, -v96, v97, v88
    v_fma_f32 v89, -v99, v97, v89
    v_fmac_f32 v96, v88, v98
    v_fmac_f32 v99, v89, v98
    v_cvt_pk_bf16_f32 v76, v96, v99
    v_sub_f32 v90, v90, v94
    v_sub_f32 v91, v91, v94
    v_cvt_pk_bf16_f32 v95, v90, v91
    v_lshlrev_b32 v90, 16, v95
    v_and_b32 v91, 0xffff0000, v95
    v_mul_f32 v96, v90, v98
    v_mul_f32 v99, v91, v98
    v_fma_f32 v90, -v96, v97, v90
    v_fma_f32 v91, -v99, v97, v91
    v_fmac_f32 v96, v90, v98
    v_fmac_f32 v99, v91, v98
    v_cvt_pk_bf16_f32 v77, v96, v99
    v_sub_f32 v92, v92, v94
    v_sub_f32 v93, v93, v94
    v_cvt_pk_bf16_f32 v95, v92, v93
    v_lshlrev_b32 v92, 16, v95
    v_and_b32 v93, 0xffff0000, v95
    v_mul_f32 v96, v92, v98
    v_mul_f32 v99, v93, v98
    v_fma_f32 v92, -v96, v97, v92
    v_fma_f32 v93, -v99, v97, v93
    v_fmac_f32 v96, v92, v98
    v_fmac_f32 v99, v93, v98
    v_cvt_pk_bf16_f32 v78, v96, v99
    ds_write_b32 v7, v72 offset:16384
    ds_write_b32 v7, v73 offset:16512
    ds_write_b32 v7, v74 offset:16640
    ds_write_b32 v7, v75 offset:16768
    ds_write_b32 v7, v76 offset:16896
    ds_write_b32 v7, v77 offset:17024
    ds_write_b32 v7, v78 offset:17152
    s_waitcnt lgkmcnt(0)
    s_barrier
    v_and_b32 v10, 7, v3
    v_mul_u32_u24 v10, 896, v10
    v_lshl_add_u32 v10, v4, 4, v10
    ds_read_b128 v[140:143], v10 offset:16384
    ds_read_b128 v[144:147], v10 offset:16448
    ds_read_b128 v[148:151], v10 offset:16512
    ds_read_b128 v[152:155], v10 offset:16576
    ds_read_b128 v[156:159], v10 offset:16640
    ds_read_b128 v[160:163], v10 offset:16704
    ds_read_b128 v[164:167], v10 offset:16768
    ds_read_b128 v[168:171], v10 offset:16832
    ds_read_b128 v[172:175], v10 offset:16896
    ds_read_b128 v[176:179], v10 offset:16960
    ds_read_b128 v[180:183], v10 offset:17024
    ds_read_b128 v[184:187], v10 offset:17088
    ds_read_b128 v[188:191], v10 offset:17152
    ds_read_b128 v[192:195], v10 offset:17216
    s_waitcnt lgkmcnt(0)
    s_barrier
    v_lshrrev_b32 v11, 2, v3
    v_lshl_add_u32 v11, v4, 3, v11
    v_lshlrev_b32 v11, 5, v11
    v_and_b32 v12, 3, v3
    v_lshl_add_u32 v11, v12, 3, v11
    s_waitcnt vmcnt(0)
    ds_read_b64_tr_b16 v[48:49], v11 offset:0
    ds_read_b64_tr_b16 v[50:51], v11 offset:128
    ds_read_b64_tr_b16 v[52:53], v11 offset:1024
    ds_read_b64_tr_b16 v[54:55], v11 offset:1152
    ds_read_b64_tr_b16 v[56:57], v11 offset:2048
    ds_read_b64_tr_b16 v[58:59], v11 offset:2176
    ds_read_b64_tr_b16 v[60:61], v11 offset:3072
    ds_read_b64_tr_b16 v[62:63], v11 offset:3200
    ds_read_b64_tr_b16 v[64:65], v11 offset:4096
    ds_read_b64_tr_b16 v[66:67], v11 offset:4224
    ds_read_b64_tr_b16 v[68:69], v11 offset:5120
    ds_read_b64_tr_b16 v[70:71], v11 offset:5248
    ds_read_b64_tr_b16 v[72:73], v11 offset:6144
    ds_read_b64_tr_b16 v[74:75], v11 offset:6272
    ds_read_b64_tr_b16 v[76:77], v11 offset:7168
    ds_read_b64_tr_b16 v[78:79], v11 offset:7296
    ds_read_b64_tr_b16 v[80:81], v11 offset:8192
    ds_read_b64_tr_b16 v[82:83], v11 offset:8320
    ds_read_b64_tr_b16 v[84:85], v11 offset:9216
    ds_read_b64_tr_b16 v[86:87], v11 offset:9344
    ds_read_b64_tr_b16 v[88:89], v11 offset:10240
    ds_read_b64_tr_b16 v[90:91], v11 offset:10368
    ds_read_b64_tr_b16 v[92:93], v11 offset:11264
    ds_read_b64_tr_b16 v[94:95], v11 offset:11392
    ds_read_b64_tr_b16 v[96:97], v11 offset:12288
    ds_read_b64_tr_b16 v[98:99], v11 offset:12416
    ds_read_b64_tr_b16 v[100:101], v11 offset:13312
    ds_read_b64_tr_b16 v[102:103], v11 offset:13440
    s_waitcnt lgkmcnt(0)
    v_mfma_f32_16x16x32_bf16 v[196:199], v[140:143], v[48:51], 0
    v_mfma_f32_16x16x32_bf16 v[196:199], v[144:147], v[52:55], v[196:199]
    v_mfma_f32_16x16x32_bf16 v[196:199], v[148:151], v[56:59], v[196:199]
    v_mfma_f32_16x16x32_bf16 v[196:199], v[152:155], v[60:63], v[196:199]
    v_mfma_f32_16x16x32_bf16 v[196:199], v[156:159], v[64:67], v[196:199]
    v_mfma_f32_16x16x32_bf16 v[196:199], v[160:163], v[68:71], v[196:199]
    v_mfma_f32_16x16x32_bf16 v[196:199], v[164:167], v[72:75], v[196:199]
    v_mfma_f32_16x16x32_bf16 v[196:199], v[168:171], v[76:79], v[196:199]
    v_mfma_f32_16x16x32_bf16 v[196:199], v[172:175], v[80:83], v[196:199]
    v_mfma_f32_16x16x32_bf16 v[196:199], v[176:179], v[84:87], v[196:199]
    v_mfma_f32_16x16x32_bf16 v[196:199], v[180:183], v[88:91], v[196:199]
    v_mfma_f32_16x16x32_bf16 v[196:199], v[184:187], v[92:95], v[196:199]
    v_mfma_f32_16x16x32_bf16 v[196:199], v[188:191], v[96:99], v[196:199]
    v_mfma_f32_16x16x32_bf16 v[196:199], v[192:195], v[100:103], v[196:199]
    v_lshlrev_b32 v10, 7, v4
    v_lshl_add_u32 v10, v3, 1, v10
    v_lshlrev_b32 v13, 4, v2
    s_nop 7
    v_cvt_pk_bf16_f32 v12, v196, v197
    v_cvt_pk_bf16_f32 v14, v198, v199
    v_cmp_gt_u32 vcc, 32, v2
    s_and_saveexec_b64 s[60:61], vcc
    ds_write_b16 v10, v12 offset:24576
    ds_write_b16_d16_hi v10, v12 offset:24608
    ds_write_b16 v10, v14 offset:24640
    ds_write_b16_d16_hi v10, v14 offset:24672
    s_mov_b64 exec, s[60:61]
    v_lshrrev_b32 v11, 1, v2
    v_lshlrev_b32 v11, 13, v11
    v_and_b32 v12, 1, v2
    v_lshl_add_u32 v11, v12, 4, v11
    v_cmp_gt_u32 vcc, 16, v2
    s_and_saveexec_b64 s[60:61], vcc
    s_waitcnt lgkmcnt(0)
    ds_read_b128 v[196:199], v13 offset:24576
    s_waitcnt lgkmcnt(0)
    buffer_store_dwordx4 v[196:199], v11, s[12:15], s55 offen sc0 sc1
    s_mov_b64 exec, s[60:61]
    s_waitcnt vmcnt(0)
    s_lshl_b32 s54, s46, 4
    v_mov_b32 v10, s54
    v_mov_b32 v11, 1
    v_cmp_eq_u32 vcc, 0, v2
    s_and_saveexec_b64 s[60:61], vcc
    buffer_atomic_add v11, v10, s[48:51], 0 offen sc0
    s_waitcnt vmcnt(0)
    v_cmp_eq_u32 vcc, 31, v11
    s_and_b64 exec, exec, vcc
    s_cbranch_execz L_notlast
    v_mov_b32 v11, 32
    buffer_store_dword v11, v10, s[48:51], 0 offen offset:128 sc0 sc1
L_notlast:
    s_mov_b64 exec, s[60:61]
    v_mov_b32 v14, 163832
    s_mov_b32 s62, 0
    s_add_u32 s26, s23, s22
    s_add_u32 s22, s22, 32768
    s_add_u32 s28, s23, s22
    s_add_u32 s22, s22, 32768
    s_mov_b32 m0, s32
    s_nop 0
    buffer_load_dwordx4 v112, s[4:7], s26 offen nt lds
    buffer_load_dwordx4 v113, s[4:7], s26 offen offset:1024 nt lds
    buffer_load_dwordx4 v114, s[4:7], s26 offen offset:2048 nt lds
    buffer_load_dwordx4 v115, s[4:7], s26 offen offset:3072 nt lds
    s_mov_b32 m0, s33
    s_nop 0
    buffer_load_dwordx4 v116, s[4:7], s26 offen nt lds
    buffer_load_dwordx4 v117, s[4:7], s26 offen offset:1024 nt lds
    buffer_load_dwordx4 v118, s[4:7], s26 offen offset:2048 nt lds
    buffer_load_dwordx4 v119, s[4:7], s26 offen offset:3072 nt lds
    s_cmp_lg_u32 s62, 0
    s_cbranch_scc1 L_rpw00
    s_waitcnt vmcnt(0)
    ds_read_b32 v15, v14
    s_waitcnt lgkmcnt(0)
    v_readfirstlane_b32 s62, v15
L_rpw00:
    s_mov_b32 m0, s36
    s_nop 0
    buffer_load_dwordx4 v120, s[8:11], s26 offen nt lds
    buffer_load_dwordx4 v121, s[8:11], s26 offen offset:1024 nt lds
    buffer_load_dwordx4 v122, s[8:11], s26 offen offset:2048 nt lds
    buffer_load_dwordx4 v123, s[8:11], s26 offen offset:3072 nt lds
    s_mov_b32 m0, s37
    s_nop 0
    buffer_load_dwordx4 v124, s[8:11], s26 offen nt lds
    buffer_load_dwordx4 v125, s[8:11], s26 offen offset:1024 nt lds
    buffer_load_dwordx4 v126, s[8:11], s26 offen offset:2048 nt lds
    buffer_load_dwordx4 v127, s[8:11], s26 offen offset:3072 nt lds
    s_cmp_lg_u32 s62, 0
    s_cbranch_scc1 L_rpw01
    s_waitcnt vmcnt(0)
    ds_read_b32 v15, v14
    s_waitcnt lgkmcnt(0)
    v_readfirstlane_b32 s62, v15
L_rpw01:
    s_mov_b32 m0, s34
    s_nop 0
    buffer_load_dwordx4 v112, s[4:7], s28 offen nt lds
    buffer_load_dwordx4 v113, s[4:7], s28 offen offset:1024 nt lds
    buffer_load_dwordx4 v114, s[4:7], s28 offen offset:2048 nt lds
    buffer_load_dwordx4 v115, s[4:7], s28 offen offset:3072 nt lds
    s_mov_b32 m0, s35
    s_nop 0
    buffer_load_dwordx4 v116, s[4:7], s28 offen nt lds
    buffer_load_dwordx4 v117, s[4:7], s28 offen offset:1024 nt lds
    buffer_load_dwordx4 v118, s[4:7], s28 offen offset:2048 nt lds
    buffer_load_dwordx4 v119, s[4:7], s28 offen offset:3072 nt lds
    s_cmp_lg_u32 s62, 0
    s_cbranch_scc1 L_rpw02
    s_waitcnt vmcnt(0)
    ds_read_b32 v15, v14
    s_waitcnt lgkmcnt(0)
    v_readfirstlane_b32 s62, v15
L_rpw02:
    s_mov_b32 m0, s38
    s_nop 0
    buffer_load_dwordx4 v120, s[8:11], s28 offen nt lds
    buffer_load_dwordx4 v121, s[8:11], s28 offen offset:1024 nt lds
    buffer_load_dwordx4 v122, s[8:11], s28 offen offset:2048 nt lds
    buffer_load_dwordx4 v123, s[8:11], s28 offen offset:3072 nt lds
    s_mov_b32 m0, s39
    s_nop 0
    buffer_load_dwordx4 v124, s[8:11], s28 offen nt lds
    buffer_load_dwordx4 v125, s[8:11], s28 offen offset:1024 nt lds
    buffer_load_dwordx4 v126, s[8:11], s28 offen offset:2048 nt lds
    buffer_load_dwordx4 v127, s[8:11], s28 offen offset:3072 nt lds
    s_mov_b32 s63, 0
L_wgw0:
    s_cmp_lg_u32 s62, 0
    s_cbranch_scc1 L_wgdw0
    s_add_u32 s63, s63, 1
    s_cmp_ge_u32 s63, 2097152
    s_cbranch_scc1 L_wgdw0
    s_sleep 1
    ds_read_b32 v15, v14
    s_waitcnt lgkmcnt(0)
    v_readfirstlane_b32 s62, v15
    s_branch L_wgw0
L_wgdw0:
    s_lshr_b32 s24, s2, 2
    s_lshl_b32 s24, s24, 10
    v_and_b32 v7, 1, v3
    v_lshlrev_b32 v7, 9, v7
    v_lshl_add_u32 v7, v4, 4, v7
    buffer_load_dwordx4 v[16:19], v7, s[12:15], s24 offen offset:0 sc0 sc1
    buffer_load_dwordx4 v[20:23], v7, s[12:15], s24 offen offset:64 sc0 sc1
    buffer_load_dwordx4 v[24:27], v7, s[12:15], s24 offen offset:128 sc0 sc1
    buffer_load_dwordx4 v[28:31], v7, s[12:15], s24 offen offset:192 sc0 sc1
    buffer_load_dwordx4 v[32:35], v7, s[12:15], s24 offen offset:256 sc0 sc1
    buffer_load_dwordx4 v[36:39], v7, s[12:15], s24 offen offset:320 sc0 sc1
    buffer_load_dwordx4 v[40:43], v7, s[12:15], s24 offen offset:384 sc0 sc1
    buffer_load_dwordx4 v[44:47], v7, s[12:15], s24 offen offset:448 sc0 sc1
    s_barrier
L_join:
    s_waitcnt vmcnt(0)
L_join2:
    v_xor_b32 v9, v4, v3
    v_and_b32 v9, 3, v9
    v_and_b32 v10, 12, v3
    v_lshlrev_b32 v11, 9, v3
    v_add_u32 v11, s25, v11
    v_xor_b32 v12, 0, v10
    v_add_u32 v12, v12, v9
    v_lshl_add_u32 v128, v12, 4, v11
    v_xor_b32 v12, 4, v10
    v_add_u32 v12, v12, v9
    v_lshl_add_u32 v129, v12, 4, v11
    v_xor_b32 v12, 8, v10
    v_add_u32 v12, v12, v9
    v_lshl_add_u32 v130, v12, 4, v11
    v_xor_b32 v12, 12, v10
    v_add_u32 v12, v12, v9
    v_lshl_add_u32 v131, v12, 4, v11
    v_lshrrev_b32 v9, 2, v3
    v_lshl_add_u32 v9, v4, 2, v9
    v_lshlrev_b32 v11, 9, v9
    v_add_u32 v11, s25, v11
    v_add_u32 v11, 16384, v11
    v_and_b32 v10, 1, v3
    v_lshl_add_u32 v11, v10, 3, v11
    v_bfe_u32 v10, v3, 1, 1
    v_lshl_add_u32 v11, v10, 4, v11
    v_and_b32 v9, 7, v9
    v_xor_b32 v12, 0, v9
    v_lshl_add_u32 v132, v12, 5, v11
    v_xor_b32 v12, 1, v9
    v_lshl_add_u32 v133, v12, 5, v11
    v_xor_b32 v12, 2, v9
    v_lshl_add_u32 v134, v12, 5, v11
    v_xor_b32 v12, 3, v9
    v_lshl_add_u32 v135, v12, 5, v11
    v_xor_b32 v12, 4, v9
    v_lshl_add_u32 v136, v12, 5, v11
    v_xor_b32 v12, 5, v9
    v_lshl_add_u32 v137, v12, 5, v11
    v_xor_b32 v12, 6, v9
    v_lshl_add_u32 v138, v12, 5, v11
    v_xor_b32 v12, 7, v9
    v_lshl_add_u32 v139, v12, 5, v11
    v_mov_b32 v48, 0
    v_mov_b32 v49, 0
    v_mov_b32 v50, 0
    v_mov_b32 v51, 0
    v_mov_b32 v52, 0
    v_mov_b32 v53, 0
    v_mov_b32 v54, 0
    v_mov_b32 v55, 0
    v_mov_b32 v56, 0
    v_mov_b32 v57, 0
    v_mov_b32 v58, 0
    v_mov_b32 v59, 0
    v_mov_b32 v60, 0
    v_mov_b32 v61, 0
    v_mov_b32 v62, 0
    v_mov_b32 v63, 0
    v_mov_b32 v64, 0
    v_mov_b32 v65, 0
    v_mov_b32 v66, 0
    v_mov_b32 v67, 0
    v_mov_b32 v68, 0
    v_mov_b32 v69, 0
    v_mov_b32 v70, 0
    v_mov_b32 v71, 0
    v_mov_b32 v72, 0
    v_mov_b32 v73, 0
    v_mov_b32 v74, 0
    v_mov_b32 v75, 0
    v_mov_b32 v76, 0
    v_mov_b32 v77, 0
    v_mov_b32 v78, 0
    v_mov_b32 v79, 0
    v_mov_b32 v80, 0
    v_mov_b32 v81, 0
    v_mov_b32 v82, 0
    v_mov_b32 v83, 0
    v_mov_b32 v84, 0
    v_mov_b32 v85, 0
    v_mov_b32 v86, 0
    v_mov_b32 v87, 0
    v_mov_b32 v88, 0
    v_mov_b32 v89, 0
    v_mov_b32 v90, 0
    v_mov_b32 v91, 0
    v_mov_b32 v92, 0
    v_mov_b32 v93, 0
    v_mov_b32 v94, 0
    v_mov_b32 v95, 0
    v_mov_b32 v96, 0
    v_mov_b32 v97, 0
    v_mov_b32 v98, 0
    v_mov_b32 v99, 0
    v_mov_b32 v100, 0
    v_mov_b32 v101, 0
    v_mov_b32 v102, 0
    v_mov_b32 v103, 0
    v_mov_b32 v104, 0
    v_mov_b32 v105, 0
    v_mov_b32 v106, 0
    v_mov_b32 v107, 0
    v_mov_b32 v108, 0
    v_mov_b32 v109, 0
    v_mov_b32 v110, 0
    v_mov_b32 v111, 0
    v_mov_b32 v208, 0xf149f2ca
    v_mov_b32 v209, 0
    s_mov_b32 s30, 0x3db8aa3b
    s_mov_b32 s24, 0
    s_lshr_b32 s31, s2, 2
    s_lshl_b32 s99, s31, 6
    s_add_u32 s99, s99, 126976
    s_add_u32 s96, s88, s99
    s_addc_u32 s97, s89, 0
    s_lshl_b32 s31, s31, 22
    s_mov_b32 s99, 1
    s_mov_b32 s100, 1
    s_mov_b32 s98, 0
L_loop:
    s_cmp_eq_u32 s99, 0
    s_cbranch_scc1 L_loop_done
    s_waitcnt vmcnt(24)
    ds_read_b128 v[140:143], v128 offset:0
    ds_read_b128 v[144:147], v129 offset:0
    ds_read_b128 v[148:151], v130 offset:0
    ds_read_b128 v[152:155], v131 offset:0
    ds_read_b128 v[156:159], v128 offset:256
    ds_read_b128 v[160:163], v129 offset:256
    ds_read_b128 v[164:167], v130 offset:256
    ds_read_b128 v[168:171], v131 offset:256
    s_waitcnt lgkmcnt(7)
    v_mfma_f32_16x16x32_bf16 v[204:207], v[140:143], v[16:19], 0
    s_waitcnt lgkmcnt(6)
    v_mfma_f32_16x16x32_bf16 v[204:207], v[144:147], v[20:23], v[204:207]
    s_waitcnt lgkmcnt(5)
    v_mfma_f32_16x16x32_bf16 v[204:207], v[148:151], v[24:27], v[204:207]
    s_waitcnt lgkmcnt(4)
    v_mfma_f32_16x16x32_bf16 v[204:207], v[152:155], v[28:31], v[204:207]
    s_waitcnt lgkmcnt(3)
    v_mfma_f32_16x16x32_bf16 v[204:207], v[156:159], v[32:35], v[204:207]
    s_waitcnt lgkmcnt(2)
    v_mfma_f32_16x16x32_bf16 v[204:207], v[160:163], v[36:39], v[204:207]
    s_waitcnt lgkmcnt(1)
    v_mfma_f32_16x16x32_bf16 v[204:207], v[164:167], v[40:43], v[204:207]
    s_waitcnt lgkmcnt(0)
    v_mfma_f32_16x16x32_bf16 v[204:207], v[168:171], v[44:47], v[204:207]
    s_cmp_lt_u32 s24, 22
    s_cbranch_scc0 L_dyn0
    s_add_u32 s29, s23, s22
    s_add_u32 s22, s22, 32768
    s_branch L_dynd0
L_dyn0:
    s_lshr_b32 s26, s98, 5
    s_lshl_b32 s26, s26, 7
    s_and_b32 s28, s98, 31
    s_add_u32 s26, s26, s28
    s_add_u32 s26, s26, 96
    s_lshl_b32 s26, s26, 13
    s_add_u32 s26, s26, s31
    s_cmp_lt_u32 s98, 128
    s_cselect_b32 s29, s26, s27
    s_cselect_b32 s99, 1, 0
L_dynd0:
    s_mov_b32 m0, s32
    s_nop 0
    buffer_load_dwordx4 v112, s[4:7], s29 offen nt lds
    buffer_load_dwordx4 v113, s[4:7], s29 offen offset:1024 nt lds
    buffer_load_dwordx4 v114, s[4:7], s29 offen offset:2048 nt lds
    buffer_load_dwordx4 v115, s[4:7], s29 offen offset:3072 nt lds
    s_mov_b32 m0, s33
    s_nop 0
    buffer_load_dwordx4 v116, s[4:7], s29 offen nt lds
    buffer_load_dwordx4 v117, s[4:7], s29 offen offset:1024 nt lds
    buffer_load_dwordx4 v118, s[4:7], s29 offen offset:2048 nt lds
    buffer_load_dwordx4 v119, s[4:7], s29 offen offset:3072 nt lds
    v_cvt_pk_bf16_f32 v210, v204, v205
    v_lshlrev_b32 v204, 16, v210
    v_and_b32 v205, 0xffff0000, v210
    v_cvt_pk_bf16_f32 v211, v206, v207
    v_lshlrev_b32 v206, 16, v211
    v_and_b32 v207, 0xffff0000, v211
    v_max3_f32 v212, v204, v205, v206
    v_max_f32 v212, v212, v207
    v_mov_b32 v213, v212
    s_nop 1
    v_permlane16_swap_b32 v212, v213
    s_nop 1
    v_max_f32 v212, v212, v213
    v_mov_b32 v213, v212
    s_nop 1
    v_permlane32_swap_b32 v212, v213
    s_nop 1
    v_max_f32 v212, v212, v213
    v_max_f32 v212, v212, v208
    v_sub_f32 v213, v208, v212
    v_mov_b32 v208, v212
    v_mul_f32 v213, s30, v213
    v_sub_f32 v204, v204, v212
    v_sub_f32 v205, v205, v212
    v_sub_f32 v206, v206, v212
    v_sub_f32 v207, v207, v212
    v_exp_f32 v213, v213
    v_mul_f32 v204, s30, v204
    v_mul_f32 v205, s30, v205
    v_mul_f32 v206, s30, v206
    v_mul_f32 v207, s30, v207
    v_exp_f32 v204, v204
    v_exp_f32 v205, v205
    v_exp_f32 v206, v206
    v_exp_f32 v207, v207
    s_nop 0
    v_add_f32 v214, v204, v205
    v_add_f32 v215, v206, v207
    v_cvt_pk_bf16_f32 v220, v204, v205
    v_cvt_pk_bf16_f32 v221, v206, v207
    v_add_f32 v214, v214, v215
    v_fma_f32 v209, v209, v213, v214
    v_mul_f32 v48, v213, v48
    v_mul_f32 v49, v213, v49
    v_mul_f32 v50, v213, v50
    v_mul_f32 v51, v213, v51
    v_mul_f32 v52, v213, v52
    v_mul_f32 v53, v213, v53
    v_mul_f32 v54, v213, v54
    v_mul_f32 v55, v213, v55
    v_mul_f32 v56, v213, v56
    v_mul_f32 v57, v213, v57
    v_mul_f32 v58, v213, v58
    v_mul_f32 v59, v213, v59
    v_mul_f32 v60, v213, v60
    v_mul_f32 v61, v213, v61
    v_mul_f32 v62, v213, v62
    v_mul_f32 v63, v213, v63
    v_mul_f32 v64, v213, v64
    v_mul_f32 v65, v213, v65
    v_mul_f32 v66, v213, v66
    v_mul_f32 v67, v213, v67
    v_mul_f32 v68, v213, v68
    v_mul_f32 v69, v213, v69
    v_mul_f32 v70, v213, v70
    v_mul_f32 v71, v213, v71
    v_mul_f32 v72, v213, v72
    v_mul_f32 v73, v213, v73
    v_mul_f32 v74, v213, v74
    v_mul_f32 v75, v213, v75
    v_mul_f32 v76, v213, v76
    v_mul_f32 v77, v213, v77
    v_mul_f32 v78, v213, v78
    v_mul_f32 v79, v213, v79
    v_mul_f32 v80, v213, v80
    v_mul_f32 v81, v213, v81
    v_mul_f32 v82, v213, v82
    v_mul_f32 v83, v213, v83
    v_mul_f32 v84, v213, v84
    v_mul_f32 v85, v213, v85
    v_mul_f32 v86, v213, v86
    v_mul_f32 v87, v213, v87
    v_mul_f32 v88, v213, v88
    v_mul_f32 v89, v213, v89
    v_mul_f32 v90, v213, v90
    v_mul_f32 v91, v213, v91
    v_mul_f32 v92, v213, v92
    v_mul_f32 v93, v213, v93
    v_mul_f32 v94, v213, v94
    v_mul_f32 v95, v213, v95
    v_mul_f32 v96, v213, v96
    v_mul_f32 v97, v213, v97
    v_mul_f32 v98, v213, v98
    v_mul_f32 v99, v213, v99
    v_mul_f32 v100, v213, v100
    v_mul_f32 v101, v213, v101
    v_mul_f32 v102, v213, v102
    v_mul_f32 v103, v213, v103
    v_mul_f32 v104, v213, v104
    v_mul_f32 v105, v213, v105
    v_mul_f32 v106, v213, v106
    v_mul_f32 v107, v213, v107
    v_mul_f32 v108, v213, v108
    v_mul_f32 v109, v213, v109
    v_mul_f32 v110, v213, v110
    v_mul_f32 v111, v213, v111
    s_waitcnt vmcnt(24)
    ds_read_b64_tr_b16 v[172:173], v132 offset:0
    ds_read_b64_tr_b16 v[174:175], v133 offset:0
    ds_read_b64_tr_b16 v[176:177], v134 offset:0
    ds_read_b64_tr_b16 v[178:179], v135 offset:0
    ds_read_b64_tr_b16 v[180:181], v136 offset:0
    ds_read_b64_tr_b16 v[182:183], v137 offset:0
    ds_read_b64_tr_b16 v[184:185], v138 offset:0
    ds_read_b64_tr_b16 v[186:187], v139 offset:0
    ds_read_b64_tr_b16 v[188:189], v132 offset:256
    ds_read_b64_tr_b16 v[190:191], v133 offset:256
    ds_read_b64_tr_b16 v[192:193], v134 offset:256
    ds_read_b64_tr_b16 v[194:195], v135 offset:256
    ds_read_b64_tr_b16 v[196:197], v136 offset:256
    ds_read_b64_tr_b16 v[198:199], v137 offset:256
    ds_read_b64_tr_b16 v[200:201], v138 offset:256
    ds_read_b64_tr_b16 v[202:203], v139 offset:256
    s_waitcnt lgkmcnt(15)
    v_mfma_f32_16x16x16_bf16 v[48:51], v[172:173], v[220:221], v[48:51]
    s_waitcnt lgkmcnt(14)
    v_mfma_f32_16x16x16_bf16 v[52:55], v[174:175], v[220:221], v[52:55]
    s_waitcnt lgkmcnt(13)
    v_mfma_f32_16x16x16_bf16 v[56:59], v[176:177], v[220:221], v[56:59]
    s_waitcnt lgkmcnt(12)
    v_mfma_f32_16x16x16_bf16 v[60:63], v[178:179], v[220:221], v[60:63]
    s_waitcnt lgkmcnt(11)
    v_mfma_f32_16x16x16_bf16 v[64:67], v[180:181], v[220:221], v[64:67]
    s_waitcnt lgkmcnt(10)
    v_mfma_f32_16x16x16_bf16 v[68:71], v[182:183], v[220:221], v[68:71]
    s_waitcnt lgkmcnt(9)
    v_mfma_f32_16x16x16_bf16 v[72:75], v[184:185], v[220:221], v[72:75]
    s_waitcnt lgkmcnt(8)
    v_mfma_f32_16x16x16_bf16 v[76:79], v[186:187], v[220:221], v[76:79]
    s_waitcnt lgkmcnt(7)
    v_mfma_f32_16x16x16_bf16 v[80:83], v[188:189], v[220:221], v[80:83]
    s_waitcnt lgkmcnt(6)
    v_mfma_f32_16x16x16_bf16 v[84:87], v[190:191], v[220:221], v[84:87]
    s_waitcnt lgkmcnt(5)
    v_mfma_f32_16x16x16_bf16 v[88:91], v[192:193], v[220:221], v[88:91]
    s_waitcnt lgkmcnt(4)
    v_mfma_f32_16x16x16_bf16 v[92:95], v[194:195], v[220:221], v[92:95]
    s_waitcnt lgkmcnt(3)
    v_mfma_f32_16x16x16_bf16 v[96:99], v[196:197], v[220:221], v[96:99]
    s_waitcnt lgkmcnt(2)
    v_mfma_f32_16x16x16_bf16 v[100:103], v[198:199], v[220:221], v[100:103]
    s_waitcnt lgkmcnt(1)
    v_mfma_f32_16x16x16_bf16 v[104:107], v[200:201], v[220:221], v[104:107]
    s_waitcnt lgkmcnt(0)
    v_mfma_f32_16x16x16_bf16 v[108:111], v[202:203], v[220:221], v[108:111]
    s_mov_b32 m0, s36
    s_nop 0
    buffer_load_dwordx4 v120, s[8:11], s29 offen nt lds
    buffer_load_dwordx4 v121, s[8:11], s29 offen offset:1024 nt lds
    buffer_load_dwordx4 v122, s[8:11], s29 offen offset:2048 nt lds
    buffer_load_dwordx4 v123, s[8:11], s29 offen offset:3072 nt lds
    s_mov_b32 m0, s37
    s_nop 0
    buffer_load_dwordx4 v124, s[8:11], s29 offen nt lds
    buffer_load_dwordx4 v125, s[8:11], s29 offen offset:1024 nt lds
    buffer_load_dwordx4 v126, s[8:11], s29 offen offset:2048 nt lds
    buffer_load_dwordx4 v127, s[8:11], s29 offen offset:3072 nt lds
    s_add_u32 s24, s24, 1
    s_cmp_lt_u32 s24, 22
    s_cbranch_scc1 L_nocl0
    s_mov_b32 s98, 1
    s_atomic_add s98, s[96:97], 0x0 glc
L_nocl0:
    s_cmp_eq_u32 s100, 0
    s_cbranch_scc1 L_loop_done
    s_waitcnt vmcnt(24)
    ds_read_b128 v[140:143], v128 offset:8192
    ds_read_b128 v[144:147], v129 offset:8192
    ds_read_b128 v[148:151], v130 offset:8192
    ds_read_b128 v[152:155], v131 offset:8192
    ds_read_b128 v[156:159], v128 offset:8448
    ds_read_b128 v[160:163], v129 offset:8448
    ds_read_b128 v[164:167], v130 offset:8448
    ds_read_b128 v[168:171], v131 offset:8448
    s_waitcnt lgkmcnt(7)
    v_mfma_f32_16x16x32_bf16 v[204:207], v[140:143], v[16:19], 0
    s_waitcnt lgkmcnt(6)
    v_mfma_f32_16x16x32_bf16 v[204:207], v[144:147], v[20:23], v[204:207]
    s_waitcnt lgkmcnt(5)
    v_mfma_f32_16x16x32_bf16 v[204:207], v[148:151], v[24:27], v[204:207]
    s_waitcnt lgkmcnt(4)
    v_mfma_f32_16x16x32_bf16 v[204:207], v[152:155], v[28:31], v[204:207]
    s_waitcnt lgkmcnt(3)
    v_mfma_f32_16x16x32_bf16 v[204:207], v[156:159], v[32:35], v[204:207]
    s_waitcnt lgkmcnt(2)
    v_mfma_f32_16x16x32_bf16 v[204:207], v[160:163], v[36:39], v[204:207]
    s_waitcnt lgkmcnt(1)
    v_mfma_f32_16x16x32_bf16 v[204:207], v[164:167], v[40:43], v[204:207]
    s_waitcnt lgkmcnt(0)
    v_mfma_f32_16x16x32_bf16 v[204:207], v[168:171], v[44:47], v[204:207]
    s_cmp_lt_u32 s24, 22
    s_cbranch_scc0 L_dyn1
    s_add_u32 s29, s23, s22
    s_add_u32 s22, s22, 32768
    s_branch L_dynd1
L_dyn1:
    s_lshr_b32 s26, s98, 5
    s_lshl_b32 s26, s26, 7
    s_and_b32 s28, s98, 31
    s_add_u32 s26, s26, s28
    s_add_u32 s26, s26, 96
    s_lshl_b32 s26, s26, 13
    s_add_u32 s26, s26, s31
    s_cmp_lt_u32 s98, 128
    s_cselect_b32 s29, s26, s27
    s_cselect_b32 s100, 1, 0
L_dynd1:
    s_mov_b32 m0, s34
    s_nop 0
    buffer_load_dwordx4 v112, s[4:7], s29 offen nt lds
    buffer_load_dwordx4 v113, s[4:7], s29 offen offset:1024 nt lds
    buffer_load_dwordx4 v114, s[4:7], s29 offen offset:2048 nt lds
    buffer_load_dwordx4 v115, s[4:7], s29 offen offset:3072 nt lds
    s_mov_b32 m0, s35
    s_nop 0
    buffer_load_dwordx4 v116, s[4:7], s29 offen nt lds
    buffer_load_dwordx4 v117, s[4:7], s29 offen offset:1024 nt lds
    buffer_load_dwordx4 v118, s[4:7], s29 offen offset:2048 nt lds
    buffer_load_dwordx4 v119, s[4:7], s29 offen offset:3072 nt lds
    v_cvt_pk_bf16_f32 v210, v204, v205
    v_lshlrev_b32 v204, 16, v210
    v_and_b32 v205, 0xffff0000, v210
    v_cvt_pk_bf16_f32 v211, v206, v207
    v_lshlrev_b32 v206, 16, v211
    v_and_b32 v207, 0xffff0000, v211
    v_max3_f32 v212, v204, v205, v206
    v_max_f32 v212, v212, v207
    v_mov_b32 v213, v212
    s_nop 1
    v_permlane16_swap_b32 v212, v213
    s_nop 1
    v_max_f32 v212, v212, v213
    v_mov_b32 v213, v212
    s_nop 1
    v_permlane32_swap_b32 v212, v213
    s_nop 1
    v_max_f32 v212, v212, v213
    v_max_f32 v212, v212, v208
    v_sub_f32 v213, v208, v212
    v_mov_b32 v208, v212
    v_mul_f32 v213, s30, v213
    v_sub_f32 v204, v204, v212
    v_sub_f32 v205, v205, v212
    v_sub_f32 v206, v206, v212
    v_sub_f32 v207, v207, v212
    v_exp_f32 v213, v213
    v_mul_f32 v204, s30, v204
    v_mul_f32 v205, s30, v205
    v_mul_f32 v206, s30, v206
    v_mul_f32 v207, s30, v207
    v_exp_f32 v204, v204
    v_exp_f32 v205, v205
    v_exp_f32 v206, v206
    v_exp_f32 v207, v207
    s_nop 0
    v_add_f32 v214, v204, v205
    v_add_f32 v215, v206, v207
    v_cvt_pk_bf16_f32 v220, v204, v205
    v_cvt_pk_bf16_f32 v221, v206, v207
    v_add_f32 v214, v214, v215
    v_fma_f32 v209, v209, v213, v214
    v_mul_f32 v48, v213, v48
    v_mul_f32 v49, v213, v49
    v_mul_f32 v50, v213, v50
    v_mul_f32 v51, v213, v51
    v_mul_f32 v52, v213, v52
    v_mul_f32 v53, v213, v53
    v_mul_f32 v54, v213, v54
    v_mul_f32 v55, v213, v55
    v_mul_f32 v56, v213, v56
    v_mul_f32 v57, v213, v57
    v_mul_f32 v58, v213, v58
    v_mul_f32 v59, v213, v59
    v_mul_f32 v60, v213, v60
    v_mul_f32 v61, v213, v61
    v_mul_f32 v62, v213, v62
    v_mul_f32 v63, v213, v63
    v_mul_f32 v64, v213, v64
    v_mul_f32 v65, v213, v65
    v_mul_f32 v66, v213, v66
    v_mul_f32 v67, v213, v67
    v_mul_f32 v68, v213, v68
    v_mul_f32 v69, v213, v69
    v_mul_f32 v70, v213, v70
    v_mul_f32 v71, v213, v71
    v_mul_f32 v72, v213, v72
    v_mul_f32 v73, v213, v73
    v_mul_f32 v74, v213, v74
    v_mul_f32 v75, v213, v75
    v_mul_f32 v76, v213, v76
    v_mul_f32 v77, v213, v77
    v_mul_f32 v78, v213, v78
    v_mul_f32 v79, v213, v79
    v_mul_f32 v80, v213, v80
    v_mul_f32 v81, v213, v81
    v_mul_f32 v82, v213, v82
    v_mul_f32 v83, v213, v83
    v_mul_f32 v84, v213, v84
    v_mul_f32 v85, v213, v85
    v_mul_f32 v86, v213, v86
    v_mul_f32 v87, v213, v87
    v_mul_f32 v88, v213, v88
    v_mul_f32 v89, v213, v89
    v_mul_f32 v90, v213, v90
    v_mul_f32 v91, v213, v91
    v_mul_f32 v92, v213, v92
    v_mul_f32 v93, v213, v93
    v_mul_f32 v94, v213, v94
    v_mul_f32 v95, v213, v95
    v_mul_f32 v96, v213, v96
    v_mul_f32 v97, v213, v97
    v_mul_f32 v98, v213, v98
    v_mul_f32 v99, v213, v99
    v_mul_f32 v100, v213, v100
    v_mul_f32 v101, v213, v101
    v_mul_f32 v102, v213, v102
    v_mul_f32 v103, v213, v103
    v_mul_f32 v104, v213, v104
    v_mul_f32 v105, v213, v105
    v_mul_f32 v106, v213, v106
    v_mul_f32 v107, v213, v107
    v_mul_f32 v108, v213, v108
    v_mul_f32 v109, v213, v109
    v_mul_f32 v110, v213, v110
    v_mul_f32 v111, v213, v111
    s_waitcnt vmcnt(24)
    ds_read_b64_tr_b16 v[172:173], v132 offset:8192
    ds_read_b64_tr_b16 v[174:175], v133 offset:8192
    ds_read_b64_tr_b16 v[176:177], v134 offset:8192
    ds_read_b64_tr_b16 v[178:179], v135 offset:8192
    ds_read_b64_tr_b16 v[180:181], v136 offset:8192
    ds_read_b64_tr_b16 v[182:183], v137 offset:8192
    ds_read_b64_tr_b16 v[184:185], v138 offset:8192
    ds_read_b64_tr_b16 v[186:187], v139 offset:8192
    ds_read_b64_tr_b16 v[188:189], v132 offset:8448
    ds_read_b64_tr_b16 v[190:191], v133 offset:8448
    ds_read_b64_tr_b16 v[192:193], v134 offset:8448
    ds_read_b64_tr_b16 v[194:195], v135 offset:8448
    ds_read_b64_tr_b16 v[196:197], v136 offset:8448
    ds_read_b64_tr_b16 v[198:199], v137 offset:8448
    ds_read_b64_tr_b16 v[200:201], v138 offset:8448
    ds_read_b64_tr_b16 v[202:203], v139 offset:8448
    s_waitcnt lgkmcnt(15)
    v_mfma_f32_16x16x16_bf16 v[48:51], v[172:173], v[220:221], v[48:51]
    s_waitcnt lgkmcnt(14)
    v_mfma_f32_16x16x16_bf16 v[52:55], v[174:175], v[220:221], v[52:55]
    s_waitcnt lgkmcnt(13)
    v_mfma_f32_16x16x16_bf16 v[56:59], v[176:177], v[220:221], v[56:59]
    s_waitcnt lgkmcnt(12)
    v_mfma_f32_16x16x16_bf16 v[60:63], v[178:179], v[220:221], v[60:63]
    s_waitcnt lgkmcnt(11)
    v_mfma_f32_16x16x16_bf16 v[64:67], v[180:181], v[220:221], v[64:67]
    s_waitcnt lgkmcnt(10)
    v_mfma_f32_16x16x16_bf16 v[68:71], v[182:183], v[220:221], v[68:71]
    s_waitcnt lgkmcnt(9)
    v_mfma_f32_16x16x16_bf16 v[72:75], v[184:185], v[220:221], v[72:75]
    s_waitcnt lgkmcnt(8)
    v_mfma_f32_16x16x16_bf16 v[76:79], v[186:187], v[220:221], v[76:79]
    s_waitcnt lgkmcnt(7)
    v_mfma_f32_16x16x16_bf16 v[80:83], v[188:189], v[220:221], v[80:83]
    s_waitcnt lgkmcnt(6)
    v_mfma_f32_16x16x16_bf16 v[84:87], v[190:191], v[220:221], v[84:87]
    s_waitcnt lgkmcnt(5)
    v_mfma_f32_16x16x16_bf16 v[88:91], v[192:193], v[220:221], v[88:91]
    s_waitcnt lgkmcnt(4)
    v_mfma_f32_16x16x16_bf16 v[92:95], v[194:195], v[220:221], v[92:95]
    s_waitcnt lgkmcnt(3)
    v_mfma_f32_16x16x16_bf16 v[96:99], v[196:197], v[220:221], v[96:99]
    s_waitcnt lgkmcnt(2)
    v_mfma_f32_16x16x16_bf16 v[100:103], v[198:199], v[220:221], v[100:103]
    s_waitcnt lgkmcnt(1)
    v_mfma_f32_16x16x16_bf16 v[104:107], v[200:201], v[220:221], v[104:107]
    s_waitcnt lgkmcnt(0)
    v_mfma_f32_16x16x16_bf16 v[108:111], v[202:203], v[220:221], v[108:111]
    s_mov_b32 m0, s38
    s_nop 0
    buffer_load_dwordx4 v120, s[8:11], s29 offen nt lds
    buffer_load_dwordx4 v121, s[8:11], s29 offen offset:1024 nt lds
    buffer_load_dwordx4 v122, s[8:11], s29 offen offset:2048 nt lds
    buffer_load_dwordx4 v123, s[8:11], s29 offen offset:3072 nt lds
    s_mov_b32 m0, s39
    s_nop 0
    buffer_load_dwordx4 v124, s[8:11], s29 offen nt lds
    buffer_load_dwordx4 v125, s[8:11], s29 offen offset:1024 nt lds
    buffer_load_dwordx4 v126, s[8:11], s29 offen offset:2048 nt lds
    buffer_load_dwordx4 v127, s[8:11], s29 offen offset:3072 nt lds
    s_add_u32 s24, s24, 1
    s_cmp_lt_u32 s24, 22
    s_cbranch_scc1 L_nocl1
    s_mov_b32 s98, 1
    s_atomic_add s98, s[96:97], 0x0 glc
L_nocl1:
    s_branch L_loop
L_loop_done:
    s_waitcnt lgkmcnt(0)
    v_mov_b32 v213, v209
    s_nop 1
    v_permlane16_swap_b32 v209, v213
    s_nop 1
    v_add_f32 v209, v209, v213
    v_mov_b32 v213, v209
    s_nop 1
    v_permlane32_swap_b32 v209, v213
    s_nop 1
    v_add_f32 v209, v209, v213
    s_waitcnt vmcnt(0)
    v_lshlrev_b32 v9, 10, v3
    v_lshl_add_u32 v9, v4, 4, v9
    v_add_u32 v9, s25, v9
    v_lshlrev_b32 v10, 3, v3
    v_add_u32 v10, s25, v10
    v_cmp_gt_u32 vcc, 2, v3
    s_and_saveexec_b64 s[40:41], vcc
    ds_write_b128 v9, v[48:51] offset:0
    ds_write_b128 v9, v[52:55] offset:64
    ds_write_b128 v9, v[56:59] offset:128
    ds_write_b128 v9, v[60:63] offset:192
    ds_write_b128 v9, v[64:67] offset:256
    ds_write_b128 v9, v[68:71] offset:320
    ds_write_b128 v9, v[72:75] offset:384
    ds_write_b128 v9, v[76:79] offset:448
    ds_write_b128 v9, v[80:83] offset:512
    ds_write_b128 v9, v[84:87] offset:576
    ds_write_b128 v9, v[88:91] offset:640
    ds_write_b128 v9, v[92:95] offset:704
    ds_write_b128 v9, v[96:99] offset:768
    ds_write_b128 v9, v[100:103] offset:832
    ds_write_b128 v9, v[104:107] offset:896
    ds_write_b128 v9, v[108:111] offset:960
    ds_write_b64 v10, v[208:209] offset:2048
    s_mov_b64 exec, s[40:41]
    s_waitcnt lgkmcnt(0)
    s_barrier
    v_lshrrev_b32 v9, 7, v0
    v_and_b32 v10, 127, v0
    v_lshlrev_b32 v11, 3, v9
    v_lshlrev_b32 v12, 10, v9
    v_lshl_add_u32 v12, v10, 3, v12
    v_add_u32 v13, 0x10000, v11
    v_add_u32 v14, 0x10000, v12
    ds_read_b64 v[20:21], v11 offset:2048
    ds_read_b64 v[22:23], v11 offset:34816
    ds_read_b64 v[24:25], v13 offset:2048
    ds_read_b64 v[26:27], v13 offset:34816
    ds_read_b64 v[30:31], v12 offset:0
    ds_read_b64 v[32:33], v12 offset:32768
    ds_read_b64 v[34:35], v14 offset:0
    ds_read_b64 v[36:37], v14 offset:32768
    s_waitcnt lgkmcnt(0)
    v_max3_f32 v40, v20, v22, v24
    v_max_f32 v40, v40, v26
    v_sub_f32 v20, v20, v40
    v_mul_f32 v20, s30, v20
    v_exp_f32 v20, v20
    v_sub_f32 v22, v22, v40
    v_mul_f32 v22, s30, v22
    v_exp_f32 v22, v22
    v_sub_f32 v24, v24, v40
    v_mul_f32 v24, s30, v24
    v_exp_f32 v24, v24
    v_sub_f32 v26, v26, v40
    v_mul_f32 v26, s30, v26
    v_exp_f32 v26, v26
    s_nop 0
    v_mul_f32 v41, v20, v21
    v_mul_f32 v42, v20, v30
    v_mul_f32 v43, v20, v31
    v_fmac_f32 v41, v22, v23
    v_fmac_f32 v42, v22, v32
    v_fmac_f32 v43, v22, v33
    v_fmac_f32 v41, v24, v25
    v_fmac_f32 v42, v24, v34
    v_fmac_f32 v43, v24, v35
    v_fmac_f32 v41, v26, v27
    v_fmac_f32 v42, v26, v36
    v_fmac_f32 v43, v26, v37
    v_or_b32 v40, 1, v40
    v_or_b32 v41, 1, v41
    v_or_b32 v42, 1, v42
    v_or_b32 v43, 1, v43
    s_lshl_b32 s24, s2, 11
    s_add_u32 s24, s24, 131072
    buffer_store_dwordx2 v[42:43], v12, s[12:15], s24 offen sc0 sc1
    s_lshl_b32 s24, s2, 4
    s_add_u32 s24, s24, 655360
    v_cmp_eq_u32 vcc, 0, v10
    s_and_saveexec_b64 s[40:41], vcc
    buffer_store_dwordx2 v[40:41], v11, s[12:15], s24 offen sc0 sc1
    s_mov_b64 exec, s[40:41]
    v_lshrrev_b32 v7, 5, v0
    v_and_b32 v8, 31, v0
    s_cmp_ge_u32 s2, 168
    s_cbranch_scc1 L_end
    s_cmp_ge_u32 s2, 161
    s_cbranch_scc1 L_final
    s_cmp_ge_u32 s44, 16
    s_cbranch_scc1 L_r_ffn
    v_lshlrev_b32 v9, 16, v7
    v_lshl_add_u32 v9, v8, 5, v9
    s_lshr_b32 s54, s44, 1
    s_lshl_b32 s54, s54, 13
    s_and_b32 s55, s44, 1
    s_lshl_b32 s56, s55, 10
    s_add_u32 s54, s54, s56
    s_add_u32 s54, s54, 131072
    s_add_u32 s57, s54, 4096
    v_lshlrev_b32 v10, 9, v7
    s_lshr_b32 s58, s44, 1
    s_lshl_b32 s58, s58, 6
    s_lshl_b32 s56, s55, 3
    s_add_u32 s58, s58, s56
    s_add_u32 s58, s58, 655360
    s_mov_b32 s59, 0
L_poll_p:
    buffer_load_dwordx4 v[16:19], v9, s[12:15], s54 offen offset:0 sc0 sc1
    buffer_load_dwordx4 v[20:23], v9, s[12:15], s54 offen offset:16 sc0 sc1
    buffer_load_dwordx4 v[24:27], v9, s[12:15], s54 offen offset:2048 sc0 sc1
    buffer_load_dwordx4 v[28:31], v9, s[12:15], s54 offen offset:2064 sc0 sc1
    buffer_load_dwordx4 v[32:35], v9, s[12:15], s57 offen offset:0 sc0 sc1
    buffer_load_dwordx4 v[36:39], v9, s[12:15], s57 offen offset:16 sc0 sc1
    buffer_load_dwordx4 v[40:43], v9, s[12:15], s57 offen offset:2048 sc0 sc1
    buffer_load_dwordx4 v[44:47], v9, s[12:15], s57 offen offset:2064 sc0 sc1
    buffer_load_dwordx2 v[48:49], v10, s[12:15], s58 offen offset:0 sc0 sc1
    buffer_load_dwordx2 v[50:51], v10, s[12:15], s58 offen offset:16 sc0 sc1
    buffer_load_dwordx2 v[52:53], v10, s[12:15], s58 offen offset:32 sc0 sc1
    buffer_load_dwordx2 v[54:55], v10, s[12:15], s58 offen offset:48 sc0 sc1
    s_waitcnt vmcnt(0)
    v_and_b32 v56, v16, v17
    v_and_b32 v57, v18, v19
    v_and_b32 v56, v56, v20
    v_and_b32 v57, v57, v21
    v_and_b32 v56, v56, v22
    v_and_b32 v57, v57, v23
    v_and_b32 v56, v56, v24
    v_and_b32 v57, v57, v25
    v_and_b32 v56, v56, v26
    v_and_b32 v57, v57, v27
    v_and_b32 v56, v56, v28
    v_and_b32 v57, v57, v29
    v_and_b32 v56, v56, v30
    v_and_b32 v57, v57, v31
    v_and_b32 v56, v56, v32
    v_and_b32 v57, v57, v33
    v_and_b32 v56, v56, v34
    v_and_b32 v57, v57, v35
    v_and_b32 v56, v56, v36
    v_and_b32 v57, v57, v37
    v_and_b32 v56, v56, v38
    v_and_b32 v57, v57, v39
    v_and_b32 v56, v56, v40
    v_and_b32 v57, v57, v41
    v_and_b32 v56, v56, v42
    v_and_b32 v57, v57, v43
    v_and_b32 v56, v56, v44
    v_and_b32 v57, v57, v45
    v_and_b32 v56, v56, v46
    v_and_b32 v57, v57, v47
    v_and_b32 v56, v56, v48
    v_and_b32 v57, v57, v49
    v_and_b32 v56, v56, v50
    v_and_b32 v57, v57, v51
    v_and_b32 v56, v56, v52
    v_and_b32 v57, v57, v53
    v_and_b32 v56, v56, v54
    v_and_b32 v57, v57, v55
    v_and_b32 v56, v56, v57
    v_and_b32 v56, 1, v56
    v_cmp_eq_u32 vcc, 0, v56
    s_cbranch_vccz L_poll_p_done
    s_add_u32 s59, s59, 1
    s_cmp_ge_u32 s59, 131072
    s_cbranch_scc1 L_poll_p_done
    s_sleep 2
    s_branch L_poll_p
L_poll_p_done:
    v_max3_f32 v56, v48, v50, v52
    v_max_f32 v56, v56, v54
    v_sub_f32 v48, v48, v56
    v_mul_f32 v48, s30, v48
    v_exp_f32 v48, v48
    v_sub_f32 v50, v50, v56
    v_mul_f32 v50, s30, v50
    v_exp_f32 v50, v50
    v_sub_f32 v52, v52, v56
    v_mul_f32 v52, s30, v52
    v_exp_f32 v52, v52
    v_sub_f32 v54, v54, v56
    v_mul_f32 v54, s30, v54
    v_exp_f32 v54, v54
    s_nop 0
    v_mul_f32 v57, v48, v49
    v_fmac_f32 v57, v50, v51
    v_fmac_f32 v57, v52, v53
    v_fmac_f32 v57, v54, v55
    v_rcp_f32 v57, v57
    s_nop 0
    v_mul_f32 v48, v48, v57
    v_mul_f32 v50, v50, v57
    v_mul_f32 v52, v52, v57
    v_mul_f32 v54, v54, v57
    v_mul_f32 v16, v48, v16
    v_fmac_f32 v16, v50, v24
    v_fmac_f32 v16, v52, v32
    v_fmac_f32 v16, v54, v40
    v_mul_f32 v17, v48, v17
    v_fmac_f32 v17, v50, v25
    v_fmac_f32 v17, v52, v33
    v_fmac_f32 v17, v54, v41
    v_mul_f32 v18, v48, v18
    v_fmac_f32 v18, v50, v26
    v_fmac_f32 v18, v52, v34
    v_fmac_f32 v18, v54, v42
    v_mul_f32 v19, v48, v19
    v_fmac_f32 v19, v50, v27
    v_fmac_f32 v19, v52, v35
    v_fmac_f32 v19, v54, v43
    v_mul_f32 v20, v48, v20
    v_fmac_f32 v20, v50, v28
    v_fmac_f32 v20, v52, v36
    v_fmac_f32 v20, v54, v44
    v_mul_f32 v21, v48, v21
    v_fmac_f32 v21, v50, v29
    v_fmac_f32 v21, v52, v37
    v_fmac_f32 v21, v54, v45
    v_mul_f32 v22, v48, v22
    v_fmac_f32 v22, v50, v30
    v_fmac_f32 v22, v52, v38
    v_fmac_f32 v22, v54, v46
    v_mul_f32 v23, v48, v23
    v_fmac_f32 v23, v50, v31
    v_fmac_f32 v23, v52, v39
    v_fmac_f32 v23, v54, v47
    v_cvt_pk_bf16_f32 v60, v16, v17
    v_cvt_pk_bf16_f32 v61, v18, v19
    v_cvt_pk_bf16_f32 v62, v20, v21
    v_cvt_pk_bf16_f32 v63, v22, v23
    s_branch L_r_act
L_r_ffn:
    v_mul_u32_u24 v9, 7168, v7
    v_lshl_add_u32 v9, v8, 5, v9
    s_sub_u32 s54, s44, 16
    s_lshl_b32 s54, s54, 10
    s_add_u32 s54, s54, 65536
    s_mov_b32 s59, 0
L_poll_h:
    buffer_load_dwordx4 v[16:19], v9, s[12:15], s54 offen sc0 sc1
    buffer_load_dwordx4 v[20:23], v9, s[12:15], s54 offen offset:16 sc0 sc1
    s_waitcnt vmcnt(0)
    v_and_b32 v56, v16, v17
    v_and_b32 v57, v18, v19
    v_and_b32 v56, v56, v20
    v_and_b32 v57, v57, v21
    v_and_b32 v56, v56, v22
    v_and_b32 v57, v57, v23
    v_and_b32 v56, v56, v57
    v_and_b32 v56, 1, v56
    v_cmp_eq_u32 vcc, 0, v56
    s_cbranch_vccz L_poll_h_done
    s_add_u32 s59, s59, 1
    s_cmp_ge_u32 s59, 131072
    s_cbranch_scc1 L_poll_h_done
    s_sleep 2
    s_branch L_poll_h
L_poll_h_done:
    v_cvt_pk_bf16_f32 v60, v16, v17
    v_cvt_pk_bf16_f32 v61, v18, v19
    v_cvt_pk_bf16_f32 v62, v20, v21
    v_cvt_pk_bf16_f32 v63, v22, v23
L_r_act:
    v_lshlrev_b32 v9, 9, v7
    v_lshl_add_u32 v9, v8, 4, v9
    ds_write_b128 v9, v[60:63] offset:4096
    s_waitcnt lgkmcnt(0)
    s_barrier
    v_and_b32 v9, 7, v3
    v_lshlrev_b32 v9, 9, v9
    v_lshl_add_u32 v9, v4, 4, v9
    v_lshrrev_b32 v10, 2, v3
    v_lshl_add_u32 v10, v4, 3, v10
    v_lshlrev_b32 v10, 7, v10
    v_and_b32 v11, 3, v3
    v_lshl_add_u32 v10, v11, 3, v10
    s_lshl_b32 s54, s3, 5
    s_add_u32 s54, s54, 131072
    v_add_u32 v10, s54, v10
    ds_read_b128 v[64:67], v9 offset:4096
    ds_read_b64_tr_b16 v[96:97], v10 offset:0
    ds_read_b64_tr_b16 v[98:99], v10 offset:512
    ds_read_b128 v[68:71], v9 offset:4160
    ds_read_b64_tr_b16 v[100:101], v10 offset:4096
    ds_read_b64_tr_b16 v[102:103], v10 offset:4608
    ds_read_b128 v[72:75], v9 offset:4224
    ds_read_b64_tr_b16 v[104:105], v10 offset:8192
    ds_read_b64_tr_b16 v[106:107], v10 offset:8704
    ds_read_b128 v[76:79], v9 offset:4288
    ds_read_b64_tr_b16 v[108:109], v10 offset:12288
    ds_read_b64_tr_b16 v[110:111], v10 offset:12800
    ds_read_b128 v[80:83], v9 offset:4352
    ds_read_b64_tr_b16 v[112:113], v10 offset:16384
    ds_read_b64_tr_b16 v[114:115], v10 offset:16896
    ds_read_b128 v[84:87], v9 offset:4416
    ds_read_b64_tr_b16 v[116:117], v10 offset:20480
    ds_read_b64_tr_b16 v[118:119], v10 offset:20992
    ds_read_b128 v[88:91], v9 offset:4480
    ds_read_b64_tr_b16 v[120:121], v10 offset:24576
    ds_read_b64_tr_b16 v[122:123], v10 offset:25088
    ds_read_b128 v[92:95], v9 offset:4544
    ds_read_b64_tr_b16 v[124:125], v10 offset:28672
    ds_read_b64_tr_b16 v[126:127], v10 offset:29184
    s_waitcnt lgkmcnt(0)
    v_mfma_f32_16x16x32_bf16 v[128:131], v[64:67], v[96:99], 0
    v_mfma_f32_16x16x32_bf16 v[128:131], v[68:71], v[100:103], v[128:131]
    v_mfma_f32_16x16x32_bf16 v[128:131], v[72:75], v[104:107], v[128:131]
    v_mfma_f32_16x16x32_bf16 v[128:131], v[76:79], v[108:111], v[128:131]
    v_mfma_f32_16x16x32_bf16 v[128:131], v[80:83], v[112:115], v[128:131]
    v_mfma_f32_16x16x32_bf16 v[128:131], v[84:87], v[116:119], v[128:131]
    v_mfma_f32_16x16x32_bf16 v[128:131], v[88:91], v[120:123], v[128:131]
    v_mfma_f32_16x16x32_bf16 v[128:131], v[92:95], v[124:127], v[128:131]
    v_lshlrev_b32 v9, 10, v4
    v_lshl_add_u32 v9, v3, 2, v9
    s_mul_i32 s54, s45, 23
    s_add_u32 s54, s54, s44
    s_lshl_b32 s54, s54, 11
    s_lshl_b32 s55, s3, 6
    s_add_u32 s54, s54, s55
    s_add_u32 s54, s54, 720896
    s_nop 4
    v_or_b32 v128, 1, v128
    v_or_b32 v129, 1, v129
    v_or_b32 v130, 1, v130
    v_or_b32 v131, 1, v131
    v_cmp_gt_u32 vcc, 32, v2
    s_and_saveexec_b64 s[40:41], vcc
    buffer_store_dword v128, v9, s[12:15], s54 offen offset:0 sc0 sc1
    buffer_store_dword v129, v9, s[12:15], s54 offen offset:256 sc0 sc1
    buffer_store_dword v130, v9, s[12:15], s54 offen offset:512 sc0 sc1
    buffer_store_dword v131, v9, s[12:15], s54 offen offset:768 sc0 sc1
    s_mov_b64 exec, s[40:41]
    s_endpgm
L_final:
    s_sub_u32 s45, s2, 161
    s_mov_b32 s20, s82
    s_and_b32 s21, s83, 0xffff
    s_mov_b32 s22, 0x380
    s_mov_b32 s23, 0x00020000
    s_mov_b32 s28, s84
    s_and_b32 s29, s85, 0xffff
    s_mov_b32 s30, 0x1c00
    s_mov_b32 s31, 0x00020000
    v_lshlrev_b32 v9, 8, v7
    v_lshl_add_u32 v9, v8, 3, v9
    v_mul_u32_u24 v10, 896, v7
    v_lshl_add_u32 v10, v8, 2, v10
    s_lshl_b32 s57, s45, 7
    v_lshlrev_b32 v11, 2, v8
    buffer_load_dword v64, v10, s[16:19], s57 offen
    buffer_load_dword v65, v11, s[20:23], s57 offen
    s_mov_b32 s59, 0
L_poll_f:
    s_mul_i32 s54, s45, 47104
    s_add_u32 s54, s54, 720896
    buffer_load_dwordx2 v[16:17], v9, s[12:15], s54 offen offset:0 sc0 sc1
    buffer_load_dwordx2 v[18:19], v9, s[12:15], s54 offen offset:2048 sc0 sc1
    s_add_u32 s54, s54, 4096
    buffer_load_dwordx2 v[20:21], v9, s[12:15], s54 offen offset:0 sc0 sc1
    buffer_load_dwordx2 v[22:23], v9, s[12:15], s54 offen offset:2048 sc0 sc1
    s_add_u32 s54, s54, 4096
    buffer_load_dwordx2 v[24:25], v9, s[12:15], s54 offen offset:0 sc0 sc1
    buffer_load_dwordx2 v[26:27], v9, s[12:15], s54 offen offset:2048 sc0 sc1
    s_add_u32 s54, s54, 4096
    buffer_load_dwordx2 v[28:29], v9, s[12:15], s54 offen offset:0 sc0 sc1
    buffer_load_dwordx2 v[30:31], v9, s[12:15], s54 offen offset:2048 sc0 sc1
    s_add_u32 s54, s54, 4096
    buffer_load_dwordx2 v[32:33], v9, s[12:15], s54 offen offset:0 sc0 sc1
    buffer_load_dwordx2 v[34:35], v9, s[12:15], s54 offen offset:2048 sc0 sc1
    s_add_u32 s54, s54, 4096
    buffer_load_dwordx2 v[36:37], v9, s[12:15], s54 offen offset:0 sc0 sc1
    buffer_load_dwordx2 v[38:39], v9, s[12:15], s54 offen offset:2048 sc0 sc1
    s_add_u32 s54, s54, 4096
    buffer_load_dwordx2 v[40:41], v9, s[12:15], s54 offen offset:0 sc0 sc1
    buffer_load_dwordx2 v[42:43], v9, s[12:15], s54 offen offset:2048 sc0 sc1
    s_add_u32 s54, s54, 4096
    buffer_load_dwordx2 v[44:45], v9, s[12:15], s54 offen offset:0 sc0 sc1
    buffer_load_dwordx2 v[46:47], v9, s[12:15], s54 offen offset:2048 sc0 sc1
    s_add_u32 s54, s54, 4096
    buffer_load_dwordx2 v[48:49], v9, s[12:15], s54 offen offset:0 sc0 sc1
    buffer_load_dwordx2 v[50:51], v9, s[12:15], s54 offen offset:2048 sc0 sc1
    s_add_u32 s54, s54, 4096
    buffer_load_dwordx2 v[52:53], v9, s[12:15], s54 offen offset:0 sc0 sc1
    buffer_load_dwordx2 v[54:55], v9, s[12:15], s54 offen offset:2048 sc0 sc1
    s_add_u32 s54, s54, 4096
    buffer_load_dwordx2 v[56:57], v9, s[12:15], s54 offen offset:0 sc0 sc1
    buffer_load_dwordx2 v[58:59], v9, s[12:15], s54 offen offset:2048 sc0 sc1
    s_add_u32 s54, s54, 4096
    buffer_load_dwordx2 v[60:61], v9, s[12:15], s54 offen offset:0 sc0 sc1
    s_waitcnt vmcnt(0)
    v_and_b32 v66, v16, v17
    v_and_b32 v67, v18, v19
    v_and_b32 v66, v66, v20
    v_and_b32 v67, v67, v21
    v_and_b32 v66, v66, v22
    v_and_b32 v67, v67, v23
    v_and_b32 v66, v66, v24
    v_and_b32 v67, v67, v25
    v_and_b32 v66, v66, v26
    v_and_b32 v67, v67, v27
    v_and_b32 v66, v66, v28
    v_and_b32 v67, v67, v29
    v_and_b32 v66, v66, v30
    v_and_b32 v67, v67, v31
    v_and_b32 v66, v66, v32
    v_and_b32 v67, v67, v33
    v_and_b32 v66, v66, v34
    v_and_b32 v67, v67, v35
    v_and_b32 v66, v66, v36
    v_and_b32 v67, v67, v37
    v_and_b32 v66, v66, v38
    v_and_b32 v67, v67, v39
    v_and_b32 v66, v66, v40
    v_and_b32 v67, v67, v41
    v_and_b32 v66, v66, v42
    v_and_b32 v67, v67, v43
    v_and_b32 v66, v66, v44
    v_and_b32 v67, v67, v45
    v_and_b32 v66, v66, v46
    v_and_b32 v67, v67, v47
    v_and_b32 v66, v66, v48
    v_and_b32 v67, v67, v49
    v_and_b32 v66, v66, v50
    v_and_b32 v67, v67, v51
    v_and_b32 v66, v66, v52
    v_and_b32 v67, v67, v53
    v_and_b32 v66, v66, v54
    v_and_b32 v67, v67, v55
    v_and_b32 v66, v66, v56
    v_and_b32 v67, v67, v57
    v_and_b32 v66, v66, v58
    v_and_b32 v67, v67, v59
    v_and_b32 v66, v66, v60
    v_and_b32 v67, v67, v61
    v_and_b32 v66, v66, v67
    v_and_b32 v66, 1, v66
    v_cmp_eq_u32 vcc, 0, v66
    s_cbranch_vccz L_poll_f_done
    s_add_u32 s59, s59, 1
    s_cmp_ge_u32 s59, 131072
    s_cbranch_scc1 L_poll_f_done
    s_sleep 2
    s_branch L_poll_f
L_poll_f_done:
    v_add_f32 v16, v16, v18
    v_add_f32 v17, v17, v19
    v_add_f32 v16, v16, v20
    v_add_f32 v17, v17, v21
    v_add_f32 v16, v16, v22
    v_add_f32 v17, v17, v23
    v_add_f32 v16, v16, v24
    v_add_f32 v17, v17, v25
    v_add_f32 v16, v16, v26
    v_add_f32 v17, v17, v27
    v_add_f32 v16, v16, v28
    v_add_f32 v17, v17, v29
    v_add_f32 v16, v16, v30
    v_add_f32 v17, v17, v31
    v_add_f32 v16, v16, v32
    v_add_f32 v17, v17, v33
    v_add_f32 v16, v16, v34
    v_add_f32 v17, v17, v35
    v_add_f32 v16, v16, v36
    v_add_f32 v17, v17, v37
    v_add_f32 v16, v16, v38
    v_add_f32 v17, v17, v39
    v_add_f32 v16, v16, v40
    v_add_f32 v17, v17, v41
    v_add_f32 v16, v16, v42
    v_add_f32 v17, v17, v43
    v_add_f32 v16, v16, v44
    v_add_f32 v17, v17, v45
    v_add_f32 v16, v16, v46
    v_add_f32 v17, v17, v47
    v_add_f32 v48, v48, v50
    v_add_f32 v49, v49, v51
    v_add_f32 v48, v48, v52
    v_add_f32 v49, v49, v53
    v_add_f32 v48, v48, v54
    v_add_f32 v49, v49, v55
    v_add_f32 v48, v48, v56
    v_add_f32 v49, v49, v57
    v_add_f32 v48, v48, v58
    v_add_f32 v49, v49, v59
    v_add_f32 v48, v48, v60
    v_add_f32 v49, v49, v61
    v_cvt_pk_bf16_f32 v12, v16, v17
    v_lshlrev_b32 v16, 16, v12
    v_and_b32 v17, 0xffff0000, v12
    v_cvt_pk_bf16_f32 v12, v48, v49
    v_lshlrev_b32 v48, 16, v12
    v_and_b32 v49, 0xffff0000, v12
    v_lshlrev_b32 v66, 16, v65
    v_and_b32 v67, 0xffff0000, v65
    v_add_f32 v48, v48, v66
    v_add_f32 v49, v49, v67
    v_cvt_pk_bf16_f32 v12, v48, v49
    v_lshlrev_b32 v48, 16, v12
    v_and_b32 v49, 0xffff0000, v12
    v_mul_f32 v12, 0xbfb8aa3b, v48
    v_exp_f32 v12, v12
    s_nop 0
    v_add_f32 v12, 1.0, v12
    v_rcp_f32 v12, v12
    s_nop 0
    v_mul_f32 v48, v48, v12
    v_mul_f32 v12, 0xbfb8aa3b, v49
    v_exp_f32 v12, v12
    s_nop 0
    v_add_f32 v12, 1.0, v12
    v_rcp_f32 v12, v12
    s_nop 0
    v_mul_f32 v49, v49, v12
    v_cvt_pk_bf16_f32 v12, v48, v49
    v_lshlrev_b32 v48, 16, v12
    v_and_b32 v49, 0xffff0000, v12
    v_mul_f32 v16, v16, v48
    v_mul_f32 v17, v17, v49
    v_cvt_pk_bf16_f32 v12, v16, v17
    v_lshlrev_b32 v16, 16, v12
    v_and_b32 v17, 0xffff0000, v12
    v_lshlrev_b32 v66, 16, v64
    v_and_b32 v67, 0xffff0000, v64
    v_add_f32 v16, v16, v66
    v_add_f32 v17, v17, v67
    v_cvt_pk_bf16_f32 v12, v16, v17
    buffer_store_dword v12, v10, s[28:31], s57 offen
L_end:
    s_endpgm
.section .rodata,"a"
.p2align 6
.amdhsa_kernel recurrent_scan__gqa_block_cached__dense_activation_gelu__decode_kernel
  .amdhsa_next_free_vgpr 224
  .amdhsa_next_free_sgpr 102
  .amdhsa_accum_offset 224
  .amdhsa_group_segment_fixed_size 0
  .amdhsa_kernarg_size 104
  .amdhsa_user_sgpr_count 2
  .amdhsa_user_sgpr_kernarg_segment_ptr 1
  .amdhsa_system_sgpr_workgroup_id_x 1
.end_amdhsa_kernel
```
